```python
import torch

def _softmax(x, axis=-1):
    return torch.softmax(x, dim=axis)
def _gelu(x):
    return torch.nn.functional.gelu(x, approximate="tanh")
def _silu(x):
    return torch.nn.functional.silu(x)
def _sigmoid(x):
    return torch.sigmoid(x)
def _layernorm(x, axis=-1, eps=1e-5):
    m = x.mean(dim=axis, keepdim=True)
    v = x.var(dim=axis, keepdim=True, unbiased=False)
    return (x - m) / torch.sqrt(v + eps)
def _scatter_add(tgt, idx, src, axis=0):
    return tgt.clone().index_add_(axis, idx, src)
def _segment_sum(src, seg, n):
    out = torch.zeros((n,) + src.shape[1:], dtype=src.dtype)
    return out.index_add_(0, seg, src)
def _pad(x, pw):
    flat = tuple(v for pair in reversed(pw) for v in pair)
    return torch.nn.functional.pad(x, flat)

kernel_name = 'gated_mix__ssm_conv_s4d__ssm_conv_h3__prompt'

def setup_inputs():

    _w = (lambda a: (lambda t: t.to(torch.bfloat16) if t.is_floating_point() else t)(torch.as_tensor(a)))
    def _A_setup():
        Bsz, L, D, N = 1, 2048, 512, 128
        return {
            "u": _w((lambda *s: torch.randn(*s, dtype=torch.bfloat16) * 0.05)(Bsz, L, D)),
            "log_A_real": _w((lambda *s: torch.randn(*s, dtype=torch.bfloat16) * 3.2)(D, N) * 0.5),
            "A_imag": _w((lambda *s: torch.randn(*s, dtype=torch.bfloat16) * 0.2)(D, N) * 3.14),
            "C_real": _w((lambda *s: torch.randn(*s, dtype=torch.bfloat16) * 3.2)(D, N) / N ** 0.5),
            "C_imag": _w((lambda *s: torch.randn(*s, dtype=torch.bfloat16) * 3.2)(D, N) / N ** 0.5),
            "log_dt": _w((lambda *s: torch.randn(*s, dtype=torch.bfloat16) * 0.2)(D) * 0.5 - 4.0),
            "D_skip": _w((lambda *s: torch.randn(*s, dtype=torch.bfloat16) * 0.4)(D)),
        }
    _A_in = _A_setup()

    def _B_setup():
        B, S, D = 1, 2048, 512
        ks = 4
        return {
            "q": _w((lambda *s: torch.randn(*s, dtype=torch.bfloat16) * 0.05)(B, S, D)),
            "k": _w((lambda *s: torch.randn(*s, dtype=torch.bfloat16) * 0.8)(B, S, D)),
            "v": _w((lambda *s: torch.randn(*s, dtype=torch.bfloat16) * 0.8)(B, S, D)),
            "shift_k": _w((lambda *s: torch.randn(*s, dtype=torch.bfloat16) * 0.8)(D, ks) * 0.5),
            "ssm_k": _w((lambda *s: torch.randn(*s, dtype=torch.bfloat16) * 0.8)(D, S) * (1.0 / S ** 0.5)),
            "ssm_D": _w((lambda *s: torch.randn(*s, dtype=torch.bfloat16) * 0.8)(D)),
        }
    _B_in = _B_setup()

    return {
        "A_u": _A_in["u"],
        "A_log_A_real": _A_in["log_A_real"],
        "A_A_imag": _A_in["A_imag"],
        "A_C_real": _A_in["C_real"],
        "A_C_imag": _A_in["C_imag"],
        "A_log_dt": _A_in["log_dt"],
        "A_D_skip": _A_in["D_skip"],
        "B_q": _B_in["q"],
        "B_k": _B_in["k"],
        "B_v": _B_in["v"],
        "B_shift_k": _B_in["shift_k"],
        "B_ssm_k": _B_in["ssm_k"],
        "B_ssm_D": _B_in["ssm_D"],
        "gate_w": _w((lambda *s: torch.randn(*s, dtype=torch.bfloat16) * 0.05)(512) * 16.0),
    }

def reference(A_u, A_log_A_real, A_A_imag, A_C_real, A_C_imag, A_log_dt, A_D_skip, B_q, B_k, B_v, B_shift_k, B_ssm_k, B_ssm_D, gate_w):
    def _A_ref(u, log_A_real, A_imag, C_real, C_imag, log_dt, D_skip):
        L = u.shape[1]
        dt = torch.exp(log_dt)
        A = -torch.exp(log_A_real) + 1j * A_imag
        C = (C_real + 1j * C_imag) * dt[:, None]
        pos = (lambda x, dt: x.to(dt))(torch.arange(L), log_dt.dtype)
        P = torch.exp((A * dt[:, None])[:, :, None] * pos[None, None, :])
        K = 2.0 * torch.einsum("dn,dnl->dl", C, P).real
        L2 = 2 * L
        u_t = (lambda x, *d: x.permute(*d))(u, 0, 2, 1)
        Kf = (lambda x, *a, **k: torch.fft.rfft(x.float(), *a, **k))(K, L2)
        Uf = (lambda x, *a, **k: torch.fft.rfft(x.float(), *a, **k))(u_t, L2)
        y = (lambda x, *a, **k: torch.fft.irfft(x, *a, **k).to(torch.bfloat16))(Uf * Kf[None, :, :], L2)[:, :, :L]
        y = (lambda x, *d: x.permute(*d))(y, 0, 2, 1)
        return y + u * D_skip[None, None, :]

    def _B_ref(q, k, v, shift_k, ssm_k, ssm_D):
        B, S, D = q.shape
        ks = shift_k.shape[-1]
        k_pad = _pad(k, ((0, 0), (ks - 1, 0), (0, 0)))
        k_shift = torch.zeros_like(k)
        for t in range(ks):
            k_shift = k_shift + k_pad[:, t:t + S, :] * shift_k[:, ks - 1 - t][None, None, :]
        kv = k_shift * v
        L = 2 * S
        kv_pad = _pad(kv, ((0, 0), (0, S), (0, 0)))
        kf_pad = _pad(ssm_k, ((0, 0), (0, S)))
        kv_f = (lambda x, axes=(-2,-1): torch.fft.rfft2(x.float(), dim=axes))(kv_pad[:, None, :, :], axes=(1, 2))
        kf_f = (lambda x, axes=(-2,-1): torch.fft.rfft2(x.float(), dim=axes))(kf_pad[:, None, :], axes=(1, 2))
        kf_f = (lambda x, *d: x.permute(*d))(kf_f, 1, 2, 0)
        y_f = kv_f * kf_f[None, :, :, :]
        y = (lambda x, s, axes=(-2,-1): torch.fft.irfft2(x, s=s, dim=axes).to(torch.bfloat16))(y_f, (1, L), axes=(1, 2))[:, 0, :S, :]
        y = y + kv * ssm_D[None, None, :]
        return q * y

    x = A_u
    g = _sigmoid((x * gate_w).sum(-1, keepdims=True))
    a = _A_ref(x, A_log_A_real, A_A_imag, A_C_real, A_C_imag, A_log_dt, A_D_skip)
    b = _B_ref(x, B_k, B_v, B_shift_k, B_ssm_k, B_ssm_D)
    return g * a + (1 - g) * b
```

```asm
; @launch grid=(256,1,1) block=(768,1,1) lds=159808
.amdgcn_target "amdgcn-amd-amdhsa--gfx950"
.text
.globl gated_mix__ssm_conv_s4d__ssm_conv_h3__prompt_kernel
.p2align 8
.type gated_mix__ssm_conv_s4d__ssm_conv_h3__prompt_kernel,@function
gated_mix__ssm_conv_s4d__ssm_conv_h3__prompt_kernel:
    s_cmp_ge_u32 s2, 256
    s_cbranch_scc1 L_end
    s_load_dwordx16 s[16:31], s[0:1], 0
    s_load_dwordx16 s[32:47], s[0:1], 64
    s_load_dwordx2 s[48:49], s[0:1], 128
    s_getpc_b64 s[12:13]
L_pc0:
    v_lshlrev_b32 v2, 5, v0
    v_min_u32 v2, L_end-L_pc0, v2
    global_load_dword v165, v2, s[12:13]
    v_lshrrev_b32 v1, 6, v0
    s_and_b32 s4, s2, 7
    v_readfirstlane_b32 s3, v1
    v_and_b32 v1, 63, v0
    v_and_b32 v0, 0xff, v0
    s_lshr_b32 s5, s2, 3
    s_lshl_b32 s6, s4, 6
    s_lshl_b32 s8, s5, 1
    s_add_u32 s6, s6, s8
    s_mov_b32 s50, 0xffff0000
    s_mov_b32 s51, 0xffff
    s_and_b32 s100, s3, 3
    s_mov_b32 s7, s4
    s_mov_b32 s98, s5
    s_lshl_b32 s99, s98, 3
    s_add_u32 s99, s99, s7
    s_cmp_ge_u32 s3, 8
    s_cbranch_scc1 L_aux
    s_cmp_ge_u32 s3, 4
    s_cbranch_scc1 L_kgen
    s_setprio 2
    v_and_b32 v57, 7, v1
    v_lshrrev_b32 v7, 3, v1
    v_xor_b32 v9, s3, v57
    s_lshl_b32 s8, s98, 16
    s_lshl_b32 s9, s7, 7
    s_add_u32 s8, s8, s9
    s_lshl_b32 s9, s3, 13
    s_add_u32 s8, s8, s9
    v_lshl_add_u32 v8, v7, 10, s8
    v_lshl_add_u32 v8, v9, 4, v8
    v_xor_b32 v58, 64, v8
    v_subrev_u32 v9, 0x8000, v58
    s_lshl_b32 s8, s3, 3
    v_add_u32 v6, s8, v7
    s_lshl_b32 s9, s7, 9
    v_lshl_add_u32 v10, v6, 4, s9
    s_movk_i32 s78, 0x1000
    s_mov_b32 s79, 0x8000
    s_lshl_b32 s11, s3, 10
    s_memrealtime s[14:15]
    s_waitcnt lgkmcnt(0)
    s_mov_b32 s56, s32
    s_and_b32 s57, s33, 0xffff
    s_mov_b32 s58, 0x200000
    s_mov_b32 s59, 0x20000
    s_cmp_lg_u32 s3, 3
    s_cbranch_scc1 L_nohalo
    s_mov_b32 m0, 134208
    s_mov_b32 exec_lo, 0
    s_mov_b32 exec_hi, 0xffffff00
    buffer_load_dwordx4 v9, s[56:59], 0 offen lds
    s_mov_b64 exec, -1
L_nohalo:
    s_add_u32 m0, s11, 135232
    s_nop 0
    buffer_load_dwordx4 v8, s[56:59], 0 offen nt lds
    s_add_u32 m0, s11, 139328
    s_nop 0
    buffer_load_dwordx4 v58, s[56:59], s79 offen nt lds
    s_mov_b32 s60, s34
    s_and_b32 s61, s35, 0xffff
    s_mov_b32 s62, 0x200000
    s_mov_b32 s63, 0x20000
    s_add_u32 m0, s11, 143424
    s_nop 0
    buffer_load_dwordx4 v8, s[60:63], 0 offen nt lds
    s_add_u32 m0, s11, 147520
    s_nop 0
    buffer_load_dwordx4 v58, s[60:63], s79 offen nt lds
    s_mov_b32 s52, s16
    s_and_b32 s53, s17, 0xffff
    s_mov_b32 s54, 0x200000
    s_mov_b32 s55, 0x20000
    s_add_u32 m0, s11, 151616
    s_nop 0
    buffer_load_dwordx4 v8, s[52:55], 0 offen nt lds
    s_add_u32 m0, s11, 155712
    s_nop 0
    buffer_load_dwordx4 v58, s[52:55], s79 offen nt lds
    global_load_dwordx4 v[48:51], v10, s[36:37]
    s_mov_b32 s72, s46
    s_and_b32 s73, s47, 0xffff
    s_mov_b32 s74, 0x100
    s_mov_b32 s75, 0x20000
    v_mov_b32 v56, 0
    s_or_b32 s8, s3, s2
    s_cmp_lg_u32 s8, 0
    s_cbranch_scc1 L_nonon
    s_or_b32 s14, s14, 1
    v_mov_b32 v52, s14
    v_mov_b32 v53, s15
    s_mov_b64 exec, 1
    buffer_store_dwordx2 v[52:53], v56, s[72:75], 0 offen sc1
    s_mov_b64 exec, -1
L_nonon:
    s_mov_b32 s64, s48
    s_and_b32 s65, s49, 0xffff
    s_mov_b32 s66, 0x800000
    s_mov_b32 s67, 0x20000
    s_mov_b32 s76, 0x05040100
    s_mov_b32 s77, 0x07060302
    s_mov_b32 s79, 0x200000
    s_mov_b32 s80, 0x201000
    s_lshl_b32 s8, s7, 18
    s_lshl_b32 s9, s98, 7
    s_add_u32 s8, s8, s9
    v_lshl_add_u32 v10, v6, 13, s8
    v_lshl_add_u32 v10, v57, 4, v10
    v_lshrrev_b32 v12, 2, v6
    v_and_b32 v13, 3, v6
    v_xor_b32 v16, v57, v12
    v_lshlrev_b32 v8, 10, v57
    v_lshl_add_u32 v8, v13, 2, v8
    v_add_u32 v8, 134208, v8
    v_add_u32 v15, 7, v57
    v_and_b32 v15, 7, v15
    v_xor_b32 v15, v15, v12
    v_lshl_add_u32 v9, v15, 4, v8
    v_lshl_add_u32 v8, v16, 4, v8
    s_lshl_b32 s8, s6, 12
    v_lshl_add_u32 v11, v0, 4, s8
    v_lshlrev_b32 v14, 4, v0
    v_add_u32 v15, 51872, v14
    v_and_b32 v19, 7, v1
    s_lshl_b32 s8, s4, 12
    s_lshl_b32 s9, s3, 10
    s_add_u32 s8, s8, s9
    s_add_u32 s8, s8, 0x410000
    v_lshl_add_u32 v19, v19, 7, s8
    s_lshl_b32 s8, s7, 12
    s_lshl_b32 s9, s98, 7
    s_add_u32 s8, s8, s9
    s_add_u32 s8, s8, 0x410000
    v_lshl_add_u32 v18, v1, 3, s8
    v_bfe_u32 v12, v1, 3, 1
    v_lshl_add_u32 v19, v12, 15, v19
    s_mul_i32 s8, s3, 25936
    v_and_b32 v12, 15, v1
    v_lshrrev_b32 v13, 4, v1
    v_and_b32 v16, 3, v12
    v_lshrrev_b32 v17, 2, v12
    v_mul_u32_u24 v2, 4160, v16
    v_lshl_add_u32 v2, v13, 4, v2
    v_lshlrev_b32 v17, 4, v17
    v_sub_u32 v2, v2, v17
    s_add_u32 s9, s8, 64
    v_add_u32 v2, s9, v2
    v_and_b32 v16, 1, v12
    v_lshrrev_b32 v17, 1, v12
    v_mul_u32_u24 v3, 4640, v16
    v_lshl_add_u32 v3, v13, 4, v3
    v_lshl_add_u32 v3, v17, 6, v3
    s_add_u32 s9, s8, 16656
    v_add_u32 v3, s9, v3
    v_mul_u32_u24 v4, 72, v17
    v_lshl_add_u32 v4, v13, 4, v4
    v_lshl_add_u32 v4, v16, 3, v4
    s_mul_i32 s9, s3, 4608
    s_add_u32 s9, s9, 134848
    v_add_u32 v4, s9, v4
    s_lshl_b32 s9, s3, 2
    s_add_u32 s9, s9, 134624
    v_mov_b32 v5, s9
    v_mov_b32 v16, 134592
    v_mov_b32 v17, 1
    s_barrier
    s_waitcnt vmcnt(0)
    s_mov_b64 exec, 1
    ds_add_u32 v16, v17 offset:4
    s_mov_b64 exec, -1
    buffer_load_dwordx2 v[52:53], v56, s[72:75], 0 offen sc1
    v_lshlrev_b32 v60, 16, v48
    v_lshlrev_b32 v61, 16, v50
    v_and_b32 v62, s50, v48
    v_and_b32 v63, s50, v50
    v_lshlrev_b32 v64, 16, v49
    v_lshlrev_b32 v65, 16, v51
    v_and_b32 v66, s50, v49
    v_and_b32 v67, s50, v51
    v_mov_b32 v12, 134596
    s_mov_b32 s91, 0
L_p1spin:
    ds_read_b32 v13, v12
    s_add_u32 s91, s91, 1
    s_waitcnt lgkmcnt(0)
    v_readfirstlane_b32 s8, v13
    s_cmp_ge_u32 s91, 0x200000
    s_cbranch_scc1 L_p1spin_done
    s_cmp_ge_u32 s8, 4
    s_cbranch_scc1 L_p1spin_done
    s_branch L_p1spin
L_p1spin_done:
    ds_read_b32 v39, v8 offset:17408
    ds_read_b32 v40, v8 offset:17536
    ds_read_b32 v41, v8 offset:17664
    ds_read_b32 v42, v8 offset:17792
    ds_read_b32 v43, v8 offset:17920
    ds_read_b32 v44, v8 offset:18048
    ds_read_b32 v45, v8 offset:18176
    ds_read_b32 v46, v8 offset:18304
    ds_read_b32 v20, v9 offset:640
    ds_read_b32 v21, v9 offset:768
    ds_read_b32 v22, v9 offset:896
    ds_read_b32 v23, v8 offset:1024
    ds_read_b32 v24, v8 offset:1152
    ds_read_b32 v25, v8 offset:1280
    ds_read_b32 v26, v8 offset:1408
    ds_read_b32 v27, v8 offset:1536
    ds_read_b32 v28, v8 offset:1664
    ds_read_b32 v29, v8 offset:1792
    ds_read_b32 v30, v8 offset:1920
    ds_read_b32 v31, v8 offset:9216
    ds_read_b32 v32, v8 offset:9344
    ds_read_b32 v33, v8 offset:9472
    ds_read_b32 v34, v8 offset:9600
    ds_read_b32 v35, v8 offset:9728
    ds_read_b32 v36, v8 offset:9856
    ds_read_b32 v37, v8 offset:9984
    ds_read_b32 v38, v8 offset:10112
    s_waitcnt lgkmcnt(15)
    v_perm_b32 v130, v40, v39, s76
    v_perm_b32 v131, v42, v41, s76
    v_perm_b32 v132, v44, v43, s76
    v_perm_b32 v133, v46, v45, s76
    buffer_store_dwordx4 v[130:133], v10, s[64:67], 0 offen sc1
    v_perm_b32 v134, v40, v39, s77
    v_perm_b32 v135, v42, v41, s77
    v_perm_b32 v136, v44, v43, s77
    v_perm_b32 v137, v46, v45, s77
    buffer_store_dwordx4 v[134:137], v10, s[64:67], s78 offen sc1
    s_waitcnt lgkmcnt(8)
    v_lshlrev_b32 v68, 16, v20
    v_and_b32 v69, s50, v20
    v_lshlrev_b32 v70, 16, v21
    v_and_b32 v71, s50, v21
    v_lshlrev_b32 v72, 16, v22
    v_and_b32 v73, s50, v22
    v_lshlrev_b32 v74, 16, v23
    v_and_b32 v75, s50, v23
    v_lshlrev_b32 v76, 16, v24
    v_and_b32 v77, s50, v24
    v_lshlrev_b32 v78, 16, v25
    v_and_b32 v79, s50, v25
    v_lshlrev_b32 v80, 16, v26
    v_and_b32 v81, s50, v26
    v_lshlrev_b32 v82, 16, v27
    v_and_b32 v83, s50, v27
    v_lshlrev_b32 v84, 16, v28
    v_and_b32 v85, s50, v28
    v_lshlrev_b32 v86, 16, v29
    v_and_b32 v87, s50, v29
    v_lshlrev_b32 v88, 16, v30
    v_and_b32 v89, s50, v30
    v_pk_mul_f32 v[90:91], v[68:69], v[66:67]
    v_pk_mul_f32 v[92:93], v[70:71], v[66:67]
    v_pk_mul_f32 v[94:95], v[72:73], v[66:67]
    v_pk_mul_f32 v[96:97], v[74:75], v[66:67]
    v_pk_mul_f32 v[98:99], v[76:77], v[66:67]
    v_pk_mul_f32 v[100:101], v[78:79], v[66:67]
    v_pk_mul_f32 v[102:103], v[80:81], v[66:67]
    v_pk_mul_f32 v[104:105], v[82:83], v[66:67]
    v_pk_fma_f32 v[90:91], v[70:71], v[64:65], v[90:91]
    v_pk_fma_f32 v[92:93], v[72:73], v[64:65], v[92:93]
    v_pk_fma_f32 v[94:95], v[74:75], v[64:65], v[94:95]
    v_pk_fma_f32 v[96:97], v[76:77], v[64:65], v[96:97]
    v_pk_fma_f32 v[98:99], v[78:79], v[64:65], v[98:99]
    v_pk_fma_f32 v[100:101], v[80:81], v[64:65], v[100:101]
    v_pk_fma_f32 v[102:103], v[82:83], v[64:65], v[102:103]
    v_pk_fma_f32 v[104:105], v[84:85], v[64:65], v[104:105]
    v_pk_fma_f32 v[90:91], v[72:73], v[62:63], v[90:91]
    v_pk_fma_f32 v[92:93], v[74:75], v[62:63], v[92:93]
    v_pk_fma_f32 v[94:95], v[76:77], v[62:63], v[94:95]
    v_pk_fma_f32 v[96:97], v[78:79], v[62:63], v[96:97]
    v_pk_fma_f32 v[98:99], v[80:81], v[62:63], v[98:99]
    v_pk_fma_f32 v[100:101], v[82:83], v[62:63], v[100:101]
    v_pk_fma_f32 v[102:103], v[84:85], v[62:63], v[102:103]
    v_pk_fma_f32 v[104:105], v[86:87], v[62:63], v[104:105]
    v_pk_fma_f32 v[90:91], v[74:75], v[60:61], v[90:91]
    v_pk_fma_f32 v[92:93], v[76:77], v[60:61], v[92:93]
    v_pk_fma_f32 v[94:95], v[78:79], v[60:61], v[94:95]
    v_pk_fma_f32 v[96:97], v[80:81], v[60:61], v[96:97]
    v_pk_fma_f32 v[98:99], v[82:83], v[60:61], v[98:99]
    v_pk_fma_f32 v[100:101], v[84:85], v[60:61], v[100:101]
    v_pk_fma_f32 v[102:103], v[86:87], v[60:61], v[102:103]
    v_pk_fma_f32 v[104:105], v[88:89], v[60:61], v[104:105]
    s_waitcnt lgkmcnt(0)
    v_lshlrev_b32 v106, 16, v31
    v_and_b32 v107, s50, v31
    v_lshlrev_b32 v108, 16, v32
    v_and_b32 v109, s50, v32
    v_lshlrev_b32 v110, 16, v33
    v_and_b32 v111, s50, v33
    v_lshlrev_b32 v112, 16, v34
    v_and_b32 v113, s50, v34
    v_lshlrev_b32 v114, 16, v35
    v_and_b32 v115, s50, v35
    v_lshlrev_b32 v116, 16, v36
    v_and_b32 v117, s50, v36
    v_lshlrev_b32 v118, 16, v37
    v_and_b32 v119, s50, v37
    v_lshlrev_b32 v120, 16, v38
    v_and_b32 v121, s50, v38
    v_pk_mul_f32 v[90:91], v[90:91], v[106:107]
    v_pk_mul_f32 v[92:93], v[92:93], v[108:109]
    v_pk_mul_f32 v[94:95], v[94:95], v[110:111]
    v_pk_mul_f32 v[96:97], v[96:97], v[112:113]
    v_pk_mul_f32 v[98:99], v[98:99], v[114:115]
    v_pk_mul_f32 v[100:101], v[100:101], v[116:117]
    v_pk_mul_f32 v[102:103], v[102:103], v[118:119]
    v_pk_mul_f32 v[104:105], v[104:105], v[120:121]
    v_cvt_pk_bf16_f32 v122, v90, v92
    v_cvt_pk_bf16_f32 v123, v94, v96
    v_cvt_pk_bf16_f32 v124, v98, v100
    v_cvt_pk_bf16_f32 v125, v102, v104
    buffer_store_dwordx4 v[122:125], v10, s[64:67], s79 offen sc1
    v_cvt_pk_bf16_f32 v126, v91, v93
    v_cvt_pk_bf16_f32 v127, v95, v97
    v_cvt_pk_bf16_f32 v128, v99, v101
    v_cvt_pk_bf16_f32 v129, v103, v105
    buffer_store_dwordx4 v[126:129], v10, s[64:67], s80 offen sc1
    s_mov_b32 s91, 0
    s_branch L_nchk_d
L_npoll_d:
    buffer_load_dwordx2 v[52:53], v56, s[72:75], 0 offen sc1
    s_add_u32 s91, s91, 1
L_nchk_d:
    s_waitcnt vmcnt(0)
    v_readfirstlane_b32 s14, v52
    v_readfirstlane_b32 s15, v53
    s_cmp_ge_u32 s91, 0x40000
    s_cbranch_scc1 L_npoll_done_d
    s_cmp_eq_u32 s14, 0
    s_cbranch_scc1 L_npoll_d
L_npoll_done_d:
    s_mov_b64 exec, 1
    ds_add_rtn_u32 v13, v16, v17
    s_waitcnt lgkmcnt(0)
    v_readfirstlane_b32 s9, v13
    s_cmp_lg_u32 s9, 3
    s_cbranch_scc1 L_nosig
    s_mov_b64 exec, 0xffff
    buffer_store_dwordx2 v[52:53], v18, s[64:67], 0 offen
L_nosig:
    s_mov_b64 exec, -1
    s_mov_b32 s91, 0
    v_mov_b32 v40, 0
L_poll:
    s_mov_b64 exec, 0xff
    buffer_load_dwordx2 v[40:41], v19, s[64:67], 0 offen nt
    s_cmp_lt_u32 s91, 8
    s_cbranch_scc1 L_noslow
    s_mov_b64 exec, 0xff00
    buffer_load_dwordx2 v[40:41], v19, s[64:67], 0 offen sc1
L_noslow:
    s_mov_b64 exec, -1
    s_add_u32 s91, s91, 1
    s_waitcnt vmcnt(0)
    v_cmp_eq_u64 vcc, s[14:15], v[40:41]
    s_cmp_ge_u32 s91, 0x40000
    s_cbranch_scc1 L_poll_done
    s_lshr_b32 s8, vcc_lo, 8
    s_or_b32 s8, s8, vcc_lo
    s_and_b32 s8, s8, 0xff
    s_cmp_lg_u32 s8, 0xff
    s_cbranch_scc1 L_poll
L_poll_done:
    buffer_load_dwordx4 v[20:23], v11, s[64:67], 0 offen sc1
    buffer_load_dwordx4 v[24:27], v11, s[64:67], s78 offen sc1
    buffer_load_dwordx4 v[28:31], v11, s[64:67], s79 offen sc1
    buffer_load_dwordx4 v[32:35], v11, s[64:67], s80 offen sc1
    s_waitcnt vmcnt(3)
    ds_write_b128 v14, v[20:23] offset:21744
    ds_write_b64 v14, v[20:21] offset:17112
    ds_write_b64 v14, v[22:23] offset:17120
    s_waitcnt vmcnt(2)
    ds_write_b128 v14, v[24:27] offset:47680
    ds_write_b64 v14, v[24:25] offset:43048
    ds_write_b64 v14, v[26:27] offset:43056
    s_waitcnt vmcnt(1)
    ds_write_b128 v15, v[28:31] offset:21744
    ds_write_b64 v15, v[28:29] offset:17112
    ds_write_b64 v15, v[30:31] offset:17120
    s_waitcnt vmcnt(0)
    ds_write_b128 v15, v[32:35] offset:47680
    ds_write_b64 v15, v[32:33] offset:43048
    ds_write_b64 v15, v[34:35] offset:43056
    s_waitcnt lgkmcnt(0)
    s_setprio 0
    s_barrier
    .p2align 3
    ds_read_b128 v[38:41], v3 offset:0
    ds_read_b128 v[42:45], v2 offset:3584
    ds_read_b128 v[46:49], v3 offset:512
    ds_read_b128 v[50:53], v2 offset:3072
    ds_read_b128 v[54:57], v3 offset:1024
    ds_read_b128 v[58:61], v2 offset:2560
    ds_read_b128 v[62:65], v3 offset:1536
    ds_read_b128 v[66:69], v2 offset:2048
    ds_read_b128 v[70:73], v3 offset:64
    s_waitcnt lgkmcnt(7)
    s_nop 0
    v_mfma_f32_16x16x32_bf16 v[6:9], v[42:45], v[38:41], 0
    ds_read_b128 v[74:77], v2 offset:3648
    s_waitcnt lgkmcnt(7)
    s_nop 0
    v_mfma_f32_16x16x32_bf16 v[10:13], v[42:45], v[46:49], 0
    ds_read_b128 v[78:81], v3 offset:576
    s_waitcnt lgkmcnt(7)
    s_nop 0
    v_mfma_f32_16x16x32_bf16 v[10:13], v[50:53], v[38:41], v[10:13]
    ds_read_b128 v[82:85], v2 offset:3136
    v_mfma_f32_16x16x32_bf16 v[14:17], v[50:53], v[46:49], 0
    s_waitcnt lgkmcnt(7)
    s_nop 0
    v_mfma_f32_16x16x32_bf16 v[14:17], v[42:45], v[54:57], v[14:17]
    ds_read_b128 v[86:89], v3 offset:1088
    s_waitcnt lgkmcnt(7)
    s_nop 0
    v_mfma_f32_16x16x32_bf16 v[14:17], v[58:61], v[38:41], v[14:17]
    ds_read_b128 v[90:93], v2 offset:2624
    v_mfma_f32_16x16x32_bf16 v[18:21], v[50:53], v[54:57], 0
    ds_read_b128 v[94:97], v3 offset:1600
    v_mfma_f32_16x16x32_bf16 v[18:21], v[58:61], v[46:49], v[18:21]
    ds_read_b128 v[98:101], v2 offset:2112
    s_waitcnt lgkmcnt(9)
    s_nop 0
    v_mfma_f32_16x16x32_bf16 v[18:21], v[42:45], v[62:65], v[18:21]
    ds_read_b128 v[102:105], v3 offset:128
    s_waitcnt lgkmcnt(9)
    s_nop 0
    v_mfma_f32_16x16x32_bf16 v[18:21], v[66:69], v[38:41], v[18:21]
    ds_read_b128 v[106:109], v2 offset:3712
    s_waitcnt lgkmcnt(8)
    s_nop 0
    v_mfma_f32_16x16x32_bf16 v[6:9], v[74:77], v[70:73], v[6:9]
    ds_read_b128 v[110:113], v3 offset:640
    s_waitcnt lgkmcnt(8)
    s_nop 0
    v_mfma_f32_16x16x32_bf16 v[10:13], v[74:77], v[78:81], v[10:13]
    ds_read_b128 v[114:117], v2 offset:3200
    s_waitcnt lgkmcnt(8)
    s_nop 0
    v_mfma_f32_16x16x32_bf16 v[10:13], v[82:85], v[70:73], v[10:13]
    ds_read_b128 v[118:121], v3 offset:1152
    v_mfma_f32_16x16x32_bf16 v[14:17], v[82:85], v[78:81], v[14:17]
    ds_read_b128 v[122:125], v2 offset:2688
    s_waitcnt lgkmcnt(9)
    s_nop 0
    v_mfma_f32_16x16x32_bf16 v[14:17], v[74:77], v[86:89], v[14:17]
    ds_read_b128 v[126:129], v3 offset:1664
    s_waitcnt lgkmcnt(9)
    s_nop 0
    v_mfma_f32_16x16x32_bf16 v[14:17], v[90:93], v[70:73], v[14:17]
    ds_read_b128 v[130:133], v2 offset:2176
    v_mfma_f32_16x16x32_bf16 v[18:21], v[82:85], v[86:89], v[18:21]
    ds_read_b128 v[134:137], v3 offset:192
    v_mfma_f32_16x16x32_bf16 v[18:21], v[90:93], v[78:81], v[18:21]
    ds_read_b128 v[138:141], v2 offset:3776
    s_waitcnt lgkmcnt(11)
    s_nop 0
    v_mfma_f32_16x16x32_bf16 v[18:21], v[74:77], v[94:97], v[18:21]
    ds_read_b128 v[142:145], v3 offset:704
    s_waitcnt lgkmcnt(11)
    s_nop 0
    v_mfma_f32_16x16x32_bf16 v[18:21], v[98:101], v[70:73], v[18:21]
    ds_read_b128 v[146:149], v2 offset:3264
    s_waitcnt lgkmcnt(10)
    s_nop 0
    v_mfma_f32_16x16x32_bf16 v[6:9], v[106:109], v[102:105], v[6:9]
    ds_read_b128 v[150:153], v3 offset:1216
    s_waitcnt lgkmcnt(10)
    s_nop 0
    v_mfma_f32_16x16x32_bf16 v[10:13], v[106:109], v[110:113], v[10:13]
    ds_read_b128 v[154:157], v2 offset:2752
    s_waitcnt lgkmcnt(10)
    s_nop 0
    v_mfma_f32_16x16x32_bf16 v[10:13], v[114:117], v[102:105], v[10:13]
    ds_read_b128 v[158:161], v3 offset:1728
    v_mfma_f32_16x16x32_bf16 v[14:17], v[114:117], v[110:113], v[14:17]
    ds_read_b128 v[162:165], v2 offset:2240
    s_waitcnt lgkmcnt(5)
    s_nop 0
    v_mfma_f32_16x16x32_bf16 v[14:17], v[106:109], v[118:121], v[14:17]
    ds_read_b128 v[50:53], v3 offset:256
    v_mfma_f32_16x16x32_bf16 v[14:17], v[122:125], v[102:105], v[14:17]
    ds_read_b128 v[54:57], v2 offset:3840
    v_mfma_f32_16x16x32_bf16 v[18:21], v[114:117], v[118:121], v[18:21]
    v_mfma_f32_16x16x32_bf16 v[18:21], v[122:125], v[110:113], v[18:21]
    ds_read_b128 v[58:61], v3 offset:768
    v_mfma_f32_16x16x32_bf16 v[18:21], v[106:109], v[126:129], v[18:21]
    ds_read_b128 v[46:49], v2 offset:3328
    v_mfma_f32_16x16x32_bf16 v[18:21], v[130:133], v[102:105], v[18:21]
    ds_read_b128 v[42:45], v3 offset:1280
    v_mfma_f32_16x16x32_bf16 v[6:9], v[138:141], v[134:137], v[6:9]
    ds_read_b128 v[62:65], v2 offset:2816
    v_mfma_f32_16x16x32_bf16 v[10:13], v[138:141], v[142:145], v[10:13]
    ds_read_b128 v[66:69], v3 offset:1792
    s_waitcnt lgkmcnt(5)
    s_nop 0
    v_mfma_f32_16x16x32_bf16 v[10:13], v[146:149], v[134:137], v[10:13]
    ds_read_b128 v[38:41], v2 offset:2304
    v_mfma_f32_16x16x32_bf16 v[14:17], v[146:149], v[142:145], v[14:17]
    ds_read_b128 v[82:85], v3 offset:320
    v_mfma_f32_16x16x32_bf16 v[14:17], v[138:141], v[150:153], v[14:17]
    ds_read_b128 v[86:89], v2 offset:3904
    v_mfma_f32_16x16x32_bf16 v[14:17], v[154:157], v[134:137], v[14:17]
    ds_read_b128 v[90:93], v3 offset:832
    v_mfma_f32_16x16x32_bf16 v[18:21], v[146:149], v[150:153], v[18:21]
    ds_read_b128 v[78:81], v2 offset:3392
    v_mfma_f32_16x16x32_bf16 v[18:21], v[154:157], v[142:145], v[18:21]
    ds_read_b128 v[74:77], v3 offset:1344
    v_mfma_f32_16x16x32_bf16 v[18:21], v[138:141], v[158:161], v[18:21]
    ds_read_b128 v[94:97], v2 offset:2880
    v_mfma_f32_16x16x32_bf16 v[18:21], v[162:165], v[134:137], v[18:21]
    ds_read_b128 v[98:101], v3 offset:1856
    v_mfma_f32_16x16x32_bf16 v[6:9], v[54:57], v[50:53], v[6:9]
    ds_read_b128 v[70:73], v2 offset:2368
    s_waitcnt lgkmcnt(5)
    s_nop 0
    v_mfma_f32_16x16x32_bf16 v[10:13], v[54:57], v[58:61], v[10:13]
    ds_read_b128 v[114:117], v3 offset:384
    v_mfma_f32_16x16x32_bf16 v[10:13], v[46:49], v[50:53], v[10:13]
    ds_read_b128 v[118:121], v2 offset:3968
    v_mfma_f32_16x16x32_bf16 v[14:17], v[46:49], v[58:61], v[14:17]
    ds_read_b128 v[122:125], v3 offset:896
    v_mfma_f32_16x16x32_bf16 v[14:17], v[54:57], v[42:45], v[14:17]
    ds_read_b128 v[110:113], v2 offset:3456
    v_mfma_f32_16x16x32_bf16 v[14:17], v[62:65], v[50:53], v[14:17]
    ds_read_b128 v[106:109], v3 offset:1408
    v_mfma_f32_16x16x32_bf16 v[18:21], v[46:49], v[42:45], v[18:21]
    ds_read_b128 v[126:129], v2 offset:2944
    v_mfma_f32_16x16x32_bf16 v[18:21], v[62:65], v[58:61], v[18:21]
    ds_read_b128 v[130:133], v3 offset:1920
    v_mfma_f32_16x16x32_bf16 v[18:21], v[54:57], v[66:69], v[18:21]
    ds_read_b128 v[102:105], v2 offset:2432
    v_mfma_f32_16x16x32_bf16 v[18:21], v[38:41], v[50:53], v[18:21]
    ds_read_b128 v[146:149], v3 offset:448
    v_mfma_f32_16x16x32_bf16 v[6:9], v[86:89], v[82:85], v[6:9]
    ds_read_b128 v[150:153], v2 offset:4032
    v_mfma_f32_16x16x32_bf16 v[10:13], v[86:89], v[90:93], v[10:13]
    ds_read_b128 v[154:157], v3 offset:960
    s_waitcnt lgkmcnt(5)
    s_nop 0
    v_mfma_f32_16x16x32_bf16 v[10:13], v[78:81], v[82:85], v[10:13]
    ds_read_b128 v[142:145], v2 offset:3520
    v_mfma_f32_16x16x32_bf16 v[14:17], v[78:81], v[90:93], v[14:17]
    v_mfma_f32_16x16x32_bf16 v[14:17], v[86:89], v[74:77], v[14:17]
    ds_read_b128 v[138:141], v3 offset:1472
    v_mfma_f32_16x16x32_bf16 v[14:17], v[94:97], v[82:85], v[14:17]
    ds_read_b128 v[158:161], v2 offset:3008
    v_mfma_f32_16x16x32_bf16 v[18:21], v[78:81], v[74:77], v[18:21]
    ds_read_b128 v[162:165], v3 offset:1984
    v_mfma_f32_16x16x32_bf16 v[18:21], v[94:97], v[90:93], v[18:21]
    ds_read_b128 v[134:137], v2 offset:2496
    v_mfma_f32_16x16x32_bf16 v[18:21], v[86:89], v[98:101], v[18:21]
    ds_read_b128 v[46:49], v3 offset:1216
    v_mfma_f32_16x16x32_bf16 v[18:21], v[70:73], v[82:85], v[18:21]
    ds_read_b128 v[42:45], v2 offset:2752
    v_mfma_f32_16x16x32_bf16 v[6:9], v[118:121], v[114:117], v[6:9]
    ds_read_b128 v[62:65], v3 offset:1728
    v_mfma_f32_16x16x32_bf16 v[10:13], v[118:121], v[122:125], v[10:13]
    ds_read_b128 v[58:61], v2 offset:3264
    v_mfma_f32_16x16x32_bf16 v[10:13], v[110:113], v[114:117], v[10:13]
    ds_read_b128 v[54:57], v3 offset:704
    v_mfma_f32_16x16x32_bf16 v[14:17], v[110:113], v[122:125], v[14:17]
    ds_read_b128 v[66:69], v2 offset:2240
    v_mfma_f32_16x16x32_bf16 v[14:17], v[118:121], v[106:109], v[14:17]
    ds_read_b128 v[38:41], v3 offset:2240
    v_mfma_f32_16x16x32_bf16 v[14:17], v[126:129], v[114:117], v[14:17]
    ds_read_b128 v[50:53], v2 offset:3776
    v_mfma_f32_16x16x32_bf16 v[18:21], v[110:113], v[106:109], v[18:21]
    ds_read_b128 v[78:81], v3 offset:192
    v_mfma_f32_16x16x32_bf16 v[18:21], v[126:129], v[122:125], v[18:21]
    ds_read_b128 v[74:77], v2 offset:1728
    s_waitcnt lgkmcnt(5)
    s_nop 0
    v_mfma_f32_16x16x32_bf16 v[18:21], v[118:121], v[130:133], v[18:21]
    ds_read_b128 v[94:97], v3 offset:2752
    v_mfma_f32_16x16x32_bf16 v[18:21], v[102:105], v[114:117], v[18:21]
    ds_read_b128 v[90:93], v2 offset:1216
    v_mfma_f32_16x16x32_bf16 v[6:9], v[150:153], v[146:149], v[6:9]
    ds_read_b128 v[86:89], v3 offset:1024
    v_mfma_f32_16x16x32_bf16 v[10:13], v[150:153], v[154:157], v[10:13]
    ds_read_b128 v[98:101], v2 offset:2560
    v_mfma_f32_16x16x32_bf16 v[10:13], v[142:145], v[146:149], v[10:13]
    ds_read_b128 v[70:73], v3 offset:1536
    v_mfma_f32_16x16x32_bf16 v[14:17], v[142:145], v[154:157], v[14:17]
    ds_read_b128 v[82:85], v2 offset:3072
    v_mfma_f32_16x16x32_bf16 v[14:17], v[150:153], v[138:141], v[14:17]
    ds_read_b128 v[110:113], v3 offset:512
    v_mfma_f32_16x16x32_bf16 v[14:17], v[158:161], v[146:149], v[14:17]
    ds_read_b128 v[106:109], v2 offset:2048
    v_mfma_f32_16x16x32_bf16 v[18:21], v[142:145], v[138:141], v[18:21]
    ds_read_b128 v[126:129], v3 offset:2048
    v_mfma_f32_16x16x32_bf16 v[18:21], v[158:161], v[154:157], v[18:21]
    ds_read_b128 v[122:125], v2 offset:3584
    v_mfma_f32_16x16x32_bf16 v[18:21], v[150:153], v[162:165], v[18:21]
    ds_read_b128 v[118:121], v3 offset:0
    v_mfma_f32_16x16x32_bf16 v[18:21], v[134:137], v[146:149], v[18:21]
    v_mfma_f32_16x16x32_bf16 v[22:25], v[42:45], v[46:49], 0
    ds_read_b128 v[130:133], v2 offset:1536
    v_mfma_f32_16x16x32_bf16 v[22:25], v[58:61], v[62:65], v[22:25]
    ds_read_b128 v[102:105], v3 offset:2560
    s_waitcnt lgkmcnt(5)
    s_nop 0
    v_mfma_f32_16x16x32_bf16 v[22:25], v[66:69], v[54:57], v[22:25]
    ds_read_b128 v[114:117], v2 offset:1024
    v_mfma_f32_16x16x32_bf16 v[26:29], v[42:45], v[62:65], 0
    v_cvt_pk_bf16_f32 v6, v6, v7
    v_cvt_pk_bf16_f32 v7, v8, v9
    ds_read_b128 v[142:145], v3 offset:3072
    v_mfma_f32_16x16x32_bf16 v[26:29], v[66:69], v[46:49], v[26:29]
    ds_write_b64 v4, v[6:7] offset:0
    v_cvt_pk_bf16_f32 v10, v10, v11
    ds_read_b128 v[138:141], v2 offset:512
    v_mfma_f32_16x16x32_bf16 v[22:25], v[50:53], v[38:41], v[22:25]
    v_cvt_pk_bf16_f32 v11, v12, v13
    ds_write_b64 v4, v[10:11] offset:576
    ds_read_b128 v[158:161], v3 offset:3584
    v_mfma_f32_16x16x32_bf16 v[22:25], v[74:77], v[78:81], v[22:25]
    v_cvt_pk_bf16_f32 v14, v14, v15
    v_cvt_pk_bf16_f32 v15, v16, v17
    ds_read_b128 v[154:157], v2 offset:0
    v_mfma_f32_16x16x32_bf16 v[26:29], v[58:61], v[38:41], v[26:29]
    ds_write_b64 v4, v[14:15] offset:1152
    v_cvt_pk_bf16_f32 v18, v18, v19
    ds_read_b128 v[150:153], v3 offset:1280
    v_mfma_f32_16x16x32_bf16 v[26:29], v[74:77], v[54:57], v[26:29]
    v_cvt_pk_bf16_f32 v19, v20, v21
    ds_write_b64 v4, v[18:19] offset:1728
    ds_read_b128 v[162:165], v2 offset:2816
    v_mfma_f32_16x16x32_bf16 v[26:29], v[50:53], v[94:97], v[26:29]
    ds_write_b32 v5, v5 offset:0
    ds_read_b128 v[134:137], v3 offset:1792
    v_mfma_f32_16x16x32_bf16 v[26:29], v[90:93], v[78:81], v[26:29]
    ds_read_b128 v[146:149], v2 offset:3328
    v_mfma_f32_16x16x32_bf16 v[22:25], v[98:101], v[86:89], v[22:25]
    ds_read_b128 v[42:45], v3 offset:768
    v_mfma_f32_16x16x32_bf16 v[22:25], v[82:85], v[70:73], v[22:25]
    ds_read_b128 v[62:65], v2 offset:2304
    v_mfma_f32_16x16x32_bf16 v[22:25], v[106:109], v[110:113], v[22:25]
    ds_read_b128 v[66:69], v3 offset:2304
    v_mfma_f32_16x16x32_bf16 v[26:29], v[98:101], v[70:73], v[26:29]
    ds_read_b128 v[46:49], v2 offset:3840
    v_mfma_f32_16x16x32_bf16 v[26:29], v[106:109], v[86:89], v[26:29]
    ds_read_b128 v[58:61], v3 offset:256
    v_mfma_f32_16x16x32_bf16 v[30:33], v[106:109], v[70:73], 0
    ds_read_b128 v[38:41], v2 offset:1792
    s_waitcnt lgkmcnt(5)
    s_nop 0
    v_mfma_f32_16x16x32_bf16 v[22:25], v[122:125], v[126:129], v[22:25]
    ds_read_b128 v[74:77], v3 offset:2816
    v_mfma_f32_16x16x32_bf16 v[22:25], v[130:133], v[118:121], v[22:25]
    ds_read_b128 v[54:57], v2 offset:1280
    v_mfma_f32_16x16x32_bf16 v[26:29], v[82:85], v[126:129], v[26:29]
    ds_read_b128 v[50:53], v3 offset:1344
    v_mfma_f32_16x16x32_bf16 v[26:29], v[130:133], v[110:113], v[26:29]
    ds_read_b128 v[94:97], v2 offset:2880
    v_mfma_f32_16x16x32_bf16 v[30:33], v[98:101], v[126:129], v[30:33]
    ds_read_b128 v[90:93], v3 offset:1856
    v_mfma_f32_16x16x32_bf16 v[30:33], v[130:133], v[86:89], v[30:33]
    ds_read_b128 v[78:81], v2 offset:3392
    v_mfma_f32_16x16x32_bf16 v[34:37], v[106:109], v[126:129], 0
    ds_read_b128 v[106:109], v3 offset:832
    v_mfma_f32_16x16x32_bf16 v[34:37], v[130:133], v[70:73], v[34:37]
    ds_read_b128 v[126:129], v2 offset:2368
    v_mfma_f32_16x16x32_bf16 v[26:29], v[122:125], v[102:105], v[26:29]
    ds_read_b128 v[130:133], v3 offset:2368
    v_mfma_f32_16x16x32_bf16 v[26:29], v[114:117], v[118:121], v[26:29]
    v_mfma_f32_16x16x32_bf16 v[30:33], v[82:85], v[102:105], v[30:33]
    ds_read_b128 v[70:73], v2 offset:3904
    v_mfma_f32_16x16x32_bf16 v[30:33], v[114:117], v[110:113], v[30:33]
    v_mfma_f32_16x16x32_bf16 v[34:37], v[98:101], v[102:105], v[34:37]
    ds_read_b128 v[98:101], v3 offset:320
    ds_read_b128 v[102:105], v2 offset:1856
    v_mfma_f32_16x16x32_bf16 v[34:37], v[114:117], v[86:89], v[34:37]
    ds_read_b128 v[114:117], v3 offset:2880
    v_mfma_f32_16x16x32_bf16 v[30:33], v[122:125], v[142:145], v[30:33]
    ds_read_b128 v[86:89], v2 offset:1344
    v_mfma_f32_16x16x32_bf16 v[30:33], v[138:141], v[118:121], v[30:33]
    v_mfma_f32_16x16x32_bf16 v[34:37], v[82:85], v[142:145], v[34:37]
    ds_read_b128 v[82:85], v3 offset:1088
    ds_read_b128 v[142:145], v2 offset:2624
    v_mfma_f32_16x16x32_bf16 v[34:37], v[138:141], v[110:113], v[34:37]
    ds_read_b128 v[138:141], v3 offset:1600
    v_mfma_f32_16x16x32_bf16 v[34:37], v[122:125], v[158:161], v[34:37]
    ds_read_b128 v[110:113], v2 offset:3136
    v_mfma_f32_16x16x32_bf16 v[34:37], v[154:157], v[118:121], v[34:37]
    ds_read_b128 v[122:125], v3 offset:576
    v_mfma_f32_16x16x32_bf16 v[22:25], v[162:165], v[150:153], v[22:25]
    ds_read_b128 v[158:161], v2 offset:2112
    v_mfma_f32_16x16x32_bf16 v[22:25], v[146:149], v[134:137], v[22:25]
    ds_read_b128 v[154:157], v3 offset:2112
    s_waitcnt lgkmcnt(5)
    s_nop 0
    v_mfma_f32_16x16x32_bf16 v[22:25], v[62:65], v[42:45], v[22:25]
    ds_read_b128 v[118:121], v2 offset:3648
    v_mfma_f32_16x16x32_bf16 v[26:29], v[162:165], v[134:137], v[26:29]
    ds_read_b128 v[162:165], v3 offset:64
    v_mfma_f32_16x16x32_bf16 v[26:29], v[62:65], v[150:153], v[26:29]
    ds_read_b128 v[134:137], v2 offset:1600
    v_mfma_f32_16x16x32_bf16 v[22:25], v[46:49], v[66:69], v[22:25]
    ds_read_b128 v[62:65], v3 offset:2624
    v_mfma_f32_16x16x32_bf16 v[22:25], v[38:41], v[58:61], v[22:25]
    ds_read_b128 v[150:153], v2 offset:1088
    v_mfma_f32_16x16x32_bf16 v[26:29], v[146:149], v[66:69], v[26:29]
    ds_read_b128 v[146:149], v3 offset:3136
    v_mfma_f32_16x16x32_bf16 v[26:29], v[38:41], v[42:45], v[26:29]
    ds_read_b128 v[66:69], v2 offset:576
    v_mfma_f32_16x16x32_bf16 v[26:29], v[46:49], v[74:77], v[26:29]
    ds_read_b128 v[38:41], v3 offset:3648
    v_mfma_f32_16x16x32_bf16 v[26:29], v[54:57], v[58:61], v[26:29]
    ds_read_b128 v[42:45], v2 offset:64
    v_mfma_f32_16x16x32_bf16 v[22:25], v[94:97], v[50:53], v[22:25]
    ds_read_b128 v[46:49], v3 offset:1408
    v_mfma_f32_16x16x32_bf16 v[22:25], v[78:81], v[90:93], v[22:25]
    ds_read_b128 v[74:77], v2 offset:2944
    v_mfma_f32_16x16x32_bf16 v[22:25], v[126:129], v[106:109], v[22:25]
    ds_read_b128 v[54:57], v3 offset:1920
    v_mfma_f32_16x16x32_bf16 v[26:29], v[94:97], v[90:93], v[26:29]
    ds_read_b128 v[58:61], v2 offset:3456
    v_mfma_f32_16x16x32_bf16 v[26:29], v[126:129], v[50:53], v[26:29]
    ds_read_b128 v[94:97], v3 offset:896
    v_mfma_f32_16x16x32_bf16 v[22:25], v[70:73], v[130:133], v[22:25]
    v_mfma_f32_16x16x32_bf16 v[22:25], v[102:105], v[98:101], v[22:25]
    ds_read_b128 v[90:93], v2 offset:2432
    v_mfma_f32_16x16x32_bf16 v[26:29], v[78:81], v[130:133], v[26:29]
    ds_read_b128 v[126:129], v3 offset:2432
    v_mfma_f32_16x16x32_bf16 v[26:29], v[102:105], v[106:109], v[26:29]
    ds_read_b128 v[50:53], v2 offset:3968
    v_mfma_f32_16x16x32_bf16 v[26:29], v[70:73], v[114:117], v[26:29]
    ds_read_b128 v[78:81], v3 offset:384
    v_mfma_f32_16x16x32_bf16 v[26:29], v[86:89], v[98:101], v[26:29]
    ds_read_b128 v[130:133], v2 offset:1920
    v_mfma_f32_16x16x32_bf16 v[22:25], v[142:145], v[82:85], v[22:25]
    ds_read_b128 v[102:105], v3 offset:2944
    s_waitcnt lgkmcnt(5)
    s_nop 0
    v_mfma_f32_16x16x32_bf16 v[22:25], v[110:113], v[138:141], v[22:25]
    ds_read_b128 v[106:109], v2 offset:1408
    v_mfma_f32_16x16x32_bf16 v[22:25], v[158:161], v[122:125], v[22:25]
    ds_read_b128 v[70:73], v3 offset:1152
    v_mfma_f32_16x16x32_bf16 v[26:29], v[142:145], v[138:141], v[26:29]
    ds_read_b128 v[114:117], v2 offset:2688
    v_mfma_f32_16x16x32_bf16 v[26:29], v[158:161], v[82:85], v[26:29]
    ds_read_b128 v[86:89], v3 offset:1664
    v_mfma_f32_16x16x32_bf16 v[30:33], v[158:161], v[138:141], v[30:33]
    ds_read_b128 v[98:101], v2 offset:3200
    v_mfma_f32_16x16x32_bf16 v[22:25], v[118:121], v[154:157], v[22:25]
    v_mfma_f32_16x16x32_bf16 v[22:25], v[134:137], v[162:165], v[22:25]
    v_mfma_f32_16x16x32_bf16 v[26:29], v[110:113], v[154:157], v[26:29]
    v_mfma_f32_16x16x32_bf16 v[26:29], v[134:137], v[122:125], v[26:29]
    v_mfma_f32_16x16x32_bf16 v[30:33], v[142:145], v[154:157], v[30:33]
    v_mfma_f32_16x16x32_bf16 v[30:33], v[134:137], v[82:85], v[30:33]
    v_mfma_f32_16x16x32_bf16 v[34:37], v[158:161], v[154:157], v[34:37]
    ds_read_b128 v[158:161], v3 offset:640
    ds_read_b128 v[154:157], v2 offset:2176
    v_mfma_f32_16x16x32_bf16 v[34:37], v[134:137], v[138:141], v[34:37]
    ds_read_b128 v[134:137], v3 offset:2176
    v_mfma_f32_16x16x32_bf16 v[26:29], v[118:121], v[62:65], v[26:29]
    ds_read_b128 v[138:141], v2 offset:3712
    v_mfma_f32_16x16x32_bf16 v[26:29], v[150:153], v[162:165], v[26:29]
    v_mfma_f32_16x16x32_bf16 v[30:33], v[110:113], v[62:65], v[30:33]
    v_mfma_f32_16x16x32_bf16 v[30:33], v[150:153], v[122:125], v[30:33]
    v_mfma_f32_16x16x32_bf16 v[34:37], v[142:145], v[62:65], v[34:37]
    ds_read_b128 v[142:145], v3 offset:128
    ds_read_b128 v[62:65], v2 offset:1664
    v_mfma_f32_16x16x32_bf16 v[34:37], v[150:153], v[82:85], v[34:37]
    ds_read_b128 v[150:153], v3 offset:2688
    v_mfma_f32_16x16x32_bf16 v[30:33], v[118:121], v[146:149], v[30:33]
    ds_read_b128 v[82:85], v2 offset:1152
    v_mfma_f32_16x16x32_bf16 v[30:33], v[66:69], v[162:165], v[30:33]
    v_mfma_f32_16x16x32_bf16 v[34:37], v[110:113], v[146:149], v[34:37]
    ds_read_b128 v[110:113], v3 offset:3200
    ds_read_b128 v[146:149], v2 offset:640
    v_mfma_f32_16x16x32_bf16 v[34:37], v[66:69], v[122:125], v[34:37]
    ds_read_b128 v[66:69], v3 offset:3712
    v_mfma_f32_16x16x32_bf16 v[34:37], v[118:121], v[38:41], v[34:37]
    ds_read_b128 v[122:125], v2 offset:128
    v_mfma_f32_16x16x32_bf16 v[34:37], v[42:45], v[162:165], v[34:37]
    ds_read_b128 v[118:121], v3 offset:1472
    v_mfma_f32_16x16x32_bf16 v[22:25], v[74:77], v[46:49], v[22:25]
    ds_read_b128 v[38:41], v2 offset:3008
    v_mfma_f32_16x16x32_bf16 v[22:25], v[58:61], v[54:57], v[22:25]
    ds_read_b128 v[42:45], v3 offset:1984
    v_mfma_f32_16x16x32_bf16 v[22:25], v[90:93], v[94:97], v[22:25]
    ds_read_b128 v[162:165], v2 offset:3520
    v_mfma_f32_16x16x32_bf16 v[26:29], v[74:77], v[54:57], v[26:29]
    ds_read_b128 v[74:77], v3 offset:960
    v_mfma_f32_16x16x32_bf16 v[26:29], v[90:93], v[46:49], v[26:29]
    ds_read_b128 v[54:57], v2 offset:2496
    s_waitcnt lgkmcnt(5)
    s_nop 0
    v_mfma_f32_16x16x32_bf16 v[22:25], v[50:53], v[126:129], v[22:25]
    ds_read_b128 v[90:93], v3 offset:2496
    v_mfma_f32_16x16x32_bf16 v[22:25], v[130:133], v[78:81], v[22:25]
    ds_read_b128 v[46:49], v2 offset:4032
    v_mfma_f32_16x16x32_bf16 v[26:29], v[58:61], v[126:129], v[26:29]
    ds_read_b128 v[58:61], v3 offset:448
    v_mfma_f32_16x16x32_bf16 v[26:29], v[130:133], v[94:97], v[26:29]
    ds_read_b128 v[126:129], v2 offset:1984
    v_mfma_f32_16x16x32_bf16 v[26:29], v[50:53], v[102:105], v[26:29]
    ds_read_b128 v[130:133], v3 offset:3008
    v_mfma_f32_16x16x32_bf16 v[26:29], v[106:109], v[78:81], v[26:29]
    ds_read_b128 v[94:97], v2 offset:1472
    v_mfma_f32_16x16x32_bf16 v[22:25], v[114:117], v[70:73], v[22:25]
    ds_read_b128 v[50:53], v3 offset:1728
    v_mfma_f32_16x16x32_bf16 v[22:25], v[98:101], v[86:89], v[22:25]
    ds_read_b128 v[102:105], v2 offset:2240
    v_mfma_f32_16x16x32_bf16 v[22:25], v[154:157], v[158:161], v[22:25]
    ds_read_b128 v[106:109], v3 offset:2240
    v_mfma_f32_16x16x32_bf16 v[26:29], v[114:117], v[86:89], v[26:29]
    ds_read_b128 v[78:81], v2 offset:2752
    v_mfma_f32_16x16x32_bf16 v[26:29], v[154:157], v[70:73], v[26:29]
    v_mfma_f32_16x16x32_bf16 v[30:33], v[154:157], v[86:89], v[30:33]
    v_mfma_f32_16x16x32_bf16 v[22:25], v[138:141], v[134:137], v[22:25]
    v_mfma_f32_16x16x32_bf16 v[22:25], v[62:65], v[142:145], v[22:25]
    v_mfma_f32_16x16x32_bf16 v[26:29], v[98:101], v[134:137], v[26:29]
    v_mfma_f32_16x16x32_bf16 v[26:29], v[62:65], v[158:161], v[26:29]
    v_mfma_f32_16x16x32_bf16 v[30:33], v[114:117], v[134:137], v[30:33]
    v_mfma_f32_16x16x32_bf16 v[30:33], v[62:65], v[70:73], v[30:33]
    v_mfma_f32_16x16x32_bf16 v[34:37], v[154:157], v[134:137], v[34:37]
    ds_read_b128 v[154:157], v3 offset:1216
    ds_read_b128 v[134:137], v2 offset:1728
    v_mfma_f32_16x16x32_bf16 v[34:37], v[62:65], v[86:89], v[34:37]
    ds_read_b128 v[62:65], v3 offset:2752
    v_mfma_f32_16x16x32_bf16 v[26:29], v[138:141], v[150:153], v[26:29]
    ds_read_b128 v[86:89], v2 offset:3264
    v_mfma_f32_16x16x32_bf16 v[26:29], v[82:85], v[142:145], v[26:29]
    v_mfma_f32_16x16x32_bf16 v[30:33], v[98:101], v[150:153], v[30:33]
    v_mfma_f32_16x16x32_bf16 v[30:33], v[82:85], v[158:161], v[30:33]
    v_mfma_f32_16x16x32_bf16 v[34:37], v[114:117], v[150:153], v[34:37]
    ds_read_b128 v[114:117], v3 offset:704
    ds_read_b128 v[150:153], v2 offset:1216
    v_mfma_f32_16x16x32_bf16 v[34:37], v[82:85], v[70:73], v[34:37]
    ds_read_b128 v[82:85], v3 offset:3264
    v_mfma_f32_16x16x32_bf16 v[30:33], v[138:141], v[110:113], v[30:33]
    ds_read_b128 v[70:73], v2 offset:3776
    v_mfma_f32_16x16x32_bf16 v[30:33], v[146:149], v[142:145], v[30:33]
    v_mfma_f32_16x16x32_bf16 v[34:37], v[98:101], v[110:113], v[34:37]
    ds_read_b128 v[98:101], v3 offset:192
    ds_read_b128 v[110:113], v2 offset:704
    v_mfma_f32_16x16x32_bf16 v[34:37], v[146:149], v[158:161], v[34:37]
    ds_read_b128 v[146:149], v3 offset:3776
    v_mfma_f32_16x16x32_bf16 v[34:37], v[138:141], v[66:69], v[34:37]
    ds_read_b128 v[158:161], v2 offset:192
    v_mfma_f32_16x16x32_bf16 v[34:37], v[122:125], v[142:145], v[34:37]
    ds_read_b128 v[138:141], v3 offset:1792
    s_waitcnt lgkmcnt(5)
    s_nop 0
    v_mfma_f32_16x16x32_bf16 v[22:25], v[38:41], v[118:121], v[22:25]
    ds_read_b128 v[66:69], v2 offset:2304
    v_mfma_f32_16x16x32_bf16 v[22:25], v[162:165], v[42:45], v[22:25]
    ds_read_b128 v[122:125], v3 offset:2304
    v_mfma_f32_16x16x32_bf16 v[22:25], v[54:57], v[74:77], v[22:25]
    ds_read_b128 v[142:145], v2 offset:2816
    v_mfma_f32_16x16x32_bf16 v[26:29], v[38:41], v[42:45], v[26:29]
    ds_read_b128 v[38:41], v3 offset:1280
    v_mfma_f32_16x16x32_bf16 v[26:29], v[54:57], v[118:121], v[26:29]
    ds_read_b128 v[42:45], v2 offset:1792
    v_mfma_f32_16x16x32_bf16 v[22:25], v[46:49], v[90:93], v[22:25]
    ds_read_b128 v[54:57], v3 offset:2816
    v_mfma_f32_16x16x32_bf16 v[22:25], v[126:129], v[58:61], v[22:25]
    ds_read_b128 v[118:121], v2 offset:3328
    v_mfma_f32_16x16x32_bf16 v[26:29], v[162:165], v[90:93], v[26:29]
    ds_read_b128 v[162:165], v3 offset:768
    v_mfma_f32_16x16x32_bf16 v[26:29], v[126:129], v[74:77], v[26:29]
    ds_read_b128 v[90:93], v2 offset:1280
    v_mfma_f32_16x16x32_bf16 v[26:29], v[46:49], v[130:133], v[26:29]
    ds_read_b128 v[126:129], v3 offset:3328
    v_mfma_f32_16x16x32_bf16 v[26:29], v[94:97], v[58:61], v[26:29]
    ds_read_b128 v[74:77], v2 offset:3840
    v_mfma_f32_16x16x32_bf16 v[30:33], v[102:105], v[50:53], v[30:33]
    ds_read_b128 v[46:49], v3 offset:256
    v_mfma_f32_16x16x32_bf16 v[30:33], v[78:81], v[106:109], v[30:33]
    ds_read_b128 v[130:133], v2 offset:768
    v_mfma_f32_16x16x32_bf16 v[30:33], v[134:137], v[154:157], v[30:33]
    ds_read_b128 v[94:97], v3 offset:3840
    v_mfma_f32_16x16x32_bf16 v[34:37], v[102:105], v[106:109], v[34:37]
    ds_read_b128 v[58:61], v2 offset:256
    v_mfma_f32_16x16x32_bf16 v[34:37], v[134:137], v[50:53], v[34:37]
    v_cvt_pk_bf16_f32 v22, v22, v23
    v_cvt_pk_bf16_f32 v23, v24, v25
    ds_read_b128 v[102:105], v3 offset:1856
    v_mfma_f32_16x16x32_bf16 v[30:33], v[86:89], v[62:65], v[30:33]
    ds_write_b64 v4, v[22:23] offset:2304
    v_cvt_pk_bf16_f32 v26, v26, v27
    ds_read_b128 v[106:109], v2 offset:2368
    v_mfma_f32_16x16x32_bf16 v[30:33], v[150:153], v[114:117], v[30:33]
    v_cvt_pk_bf16_f32 v27, v28, v29
    ds_write_b64 v4, v[26:27] offset:2880
    ds_read_b128 v[134:137], v3 offset:2368
    v_mfma_f32_16x16x32_bf16 v[34:37], v[78:81], v[62:65], v[34:37]
    ds_write_b32 v5, v5 offset:16
    ds_read_b128 v[50:53], v2 offset:2880
    v_mfma_f32_16x16x32_bf16 v[34:37], v[150:153], v[154:157], v[34:37]
    v_mfma_f32_16x16x32_bf16 v[30:33], v[70:73], v[82:85], v[30:33]
    ds_read_b128 v[78:81], v3 offset:1344
    s_waitcnt lgkmcnt(5)
    s_nop 0
    v_mfma_f32_16x16x32_bf16 v[30:33], v[110:113], v[98:101], v[30:33]
    ds_read_b128 v[62:65], v2 offset:1856
    v_mfma_f32_16x16x32_bf16 v[34:37], v[86:89], v[82:85], v[34:37]
    ds_read_b128 v[150:153], v3 offset:2880
    v_mfma_f32_16x16x32_bf16 v[34:37], v[110:113], v[114:117], v[34:37]
    ds_read_b128 v[154:157], v2 offset:3392
    v_mfma_f32_16x16x32_bf16 v[34:37], v[70:73], v[146:149], v[34:37]
    ds_read_b128 v[86:89], v3 offset:832
    v_mfma_f32_16x16x32_bf16 v[34:37], v[158:161], v[98:101], v[34:37]
    ds_read_b128 v[82:85], v2 offset:1344
    v_mfma_f32_16x16x32_bf16 v[30:33], v[66:69], v[138:141], v[30:33]
    ds_read_b128 v[110:113], v3 offset:3392
    v_mfma_f32_16x16x32_bf16 v[30:33], v[142:145], v[122:125], v[30:33]
    ds_read_b128 v[114:117], v2 offset:3904
    v_mfma_f32_16x16x32_bf16 v[30:33], v[42:45], v[38:41], v[30:33]
    ds_read_b128 v[70:73], v3 offset:320
    v_mfma_f32_16x16x32_bf16 v[34:37], v[66:69], v[122:125], v[34:37]
    ds_read_b128 v[146:149], v2 offset:832
    v_mfma_f32_16x16x32_bf16 v[34:37], v[42:45], v[138:141], v[34:37]
    ds_read_b128 v[158:161], v3 offset:3904
    v_mfma_f32_16x16x32_bf16 v[30:33], v[118:121], v[54:57], v[30:33]
    ds_read_b128 v[98:101], v2 offset:320
    v_mfma_f32_16x16x32_bf16 v[30:33], v[90:93], v[162:165], v[30:33]
    ds_read_b128 v[66:69], v3 offset:1920
    v_mfma_f32_16x16x32_bf16 v[34:37], v[142:145], v[54:57], v[34:37]
    ds_read_b128 v[122:125], v2 offset:2432
    v_mfma_f32_16x16x32_bf16 v[34:37], v[90:93], v[38:41], v[34:37]
    ds_read_b128 v[42:45], v3 offset:2432
    v_mfma_f32_16x16x32_bf16 v[30:33], v[74:77], v[126:129], v[30:33]
    ds_read_b128 v[138:141], v2 offset:2944
    v_mfma_f32_16x16x32_bf16 v[30:33], v[130:133], v[46:49], v[30:33]
    ds_read_b128 v[142:145], v3 offset:1408
    v_mfma_f32_16x16x32_bf16 v[34:37], v[118:121], v[126:129], v[34:37]
    ds_read_b128 v[54:57], v2 offset:1920
    v_mfma_f32_16x16x32_bf16 v[34:37], v[130:133], v[162:165], v[34:37]
    ds_read_b128 v[90:93], v3 offset:2944
    v_mfma_f32_16x16x32_bf16 v[34:37], v[74:77], v[94:97], v[34:37]
    ds_read_b128 v[38:41], v2 offset:3456
    v_mfma_f32_16x16x32_bf16 v[34:37], v[58:61], v[46:49], v[34:37]
    ds_read_b128 v[118:121], v3 offset:896
    v_mfma_f32_16x16x32_bf16 v[30:33], v[106:109], v[102:105], v[30:33]
    ds_read_b128 v[126:129], v2 offset:1408
    s_waitcnt lgkmcnt(5)
    s_nop 0
    v_mfma_f32_16x16x32_bf16 v[30:33], v[50:53], v[134:137], v[30:33]
    ds_read_b128 v[130:133], v3 offset:3456
    v_mfma_f32_16x16x32_bf16 v[30:33], v[62:65], v[78:81], v[30:33]
    ds_read_b128 v[162:165], v2 offset:3968
    v_mfma_f32_16x16x32_bf16 v[34:37], v[106:109], v[134:137], v[34:37]
    ds_read_b128 v[74:77], v3 offset:384
    v_mfma_f32_16x16x32_bf16 v[34:37], v[62:65], v[102:105], v[34:37]
    ds_read_b128 v[94:97], v2 offset:896
    v_mfma_f32_16x16x32_bf16 v[30:33], v[154:157], v[150:153], v[30:33]
    v_mfma_f32_16x16x32_bf16 v[30:33], v[82:85], v[86:89], v[30:33]
    ds_read_b128 v[58:61], v3 offset:3968
    v_mfma_f32_16x16x32_bf16 v[34:37], v[50:53], v[150:153], v[34:37]
    ds_read_b128 v[46:49], v2 offset:384
    v_mfma_f32_16x16x32_bf16 v[34:37], v[82:85], v[78:81], v[34:37]
    ds_read_b128 v[106:109], v3 offset:1984
    v_mfma_f32_16x16x32_bf16 v[30:33], v[114:117], v[110:113], v[30:33]
    ds_read_b128 v[134:137], v2 offset:2496
    v_mfma_f32_16x16x32_bf16 v[30:33], v[146:149], v[70:73], v[30:33]
    ds_read_b128 v[62:65], v3 offset:2496
    v_mfma_f32_16x16x32_bf16 v[34:37], v[154:157], v[110:113], v[34:37]
    ds_read_b128 v[102:105], v2 offset:3008
    v_mfma_f32_16x16x32_bf16 v[34:37], v[146:149], v[86:89], v[34:37]
    ds_read_b128 v[50:53], v3 offset:1472
    v_mfma_f32_16x16x32_bf16 v[34:37], v[114:117], v[158:161], v[34:37]
    ds_read_b128 v[150:153], v2 offset:1984
    v_mfma_f32_16x16x32_bf16 v[34:37], v[98:101], v[70:73], v[34:37]
    ds_read_b128 v[82:85], v3 offset:3008
    v_mfma_f32_16x16x32_bf16 v[30:33], v[122:125], v[66:69], v[30:33]
    ds_read_b128 v[78:81], v2 offset:3520
    v_mfma_f32_16x16x32_bf16 v[30:33], v[138:141], v[42:45], v[30:33]
    ds_read_b128 v[154:157], v3 offset:960
    s_waitcnt lgkmcnt(5)
    s_nop 0
    v_mfma_f32_16x16x32_bf16 v[30:33], v[54:57], v[142:145], v[30:33]
    ds_read_b128 v[110:113], v2 offset:1472
    v_mfma_f32_16x16x32_bf16 v[34:37], v[122:125], v[42:45], v[34:37]
    ds_read_b128 v[146:149], v3 offset:3520
    v_mfma_f32_16x16x32_bf16 v[34:37], v[54:57], v[66:69], v[34:37]
    ds_read_b128 v[86:89], v2 offset:4032
    v_mfma_f32_16x16x32_bf16 v[30:33], v[38:41], v[90:93], v[30:33]
    ds_read_b128 v[114:117], v3 offset:448
    v_mfma_f32_16x16x32_bf16 v[30:33], v[126:129], v[118:121], v[30:33]
    ds_read_b128 v[158:161], v2 offset:960
    v_mfma_f32_16x16x32_bf16 v[34:37], v[138:141], v[90:93], v[34:37]
    ds_read_b128 v[98:101], v3 offset:4032
    v_mfma_f32_16x16x32_bf16 v[34:37], v[126:129], v[142:145], v[34:37]
    ds_read_b128 v[70:73], v2 offset:448
    v_mfma_f32_16x16x32_bf16 v[30:33], v[162:165], v[130:133], v[30:33]
    v_mfma_f32_16x16x32_bf16 v[30:33], v[94:97], v[74:77], v[30:33]
    v_mfma_f32_16x16x32_bf16 v[34:37], v[38:41], v[130:133], v[34:37]
    v_mfma_f32_16x16x32_bf16 v[34:37], v[94:97], v[118:121], v[34:37]
    v_mfma_f32_16x16x32_bf16 v[34:37], v[162:165], v[58:61], v[34:37]
    v_mfma_f32_16x16x32_bf16 v[34:37], v[46:49], v[74:77], v[34:37]
    v_mfma_f32_16x16x32_bf16 v[30:33], v[134:137], v[106:109], v[30:33]
    v_mfma_f32_16x16x32_bf16 v[30:33], v[102:105], v[62:65], v[30:33]
    s_waitcnt lgkmcnt(5)
    s_nop 0
    v_mfma_f32_16x16x32_bf16 v[30:33], v[150:153], v[50:53], v[30:33]
    v_mfma_f32_16x16x32_bf16 v[34:37], v[134:137], v[62:65], v[34:37]
    v_mfma_f32_16x16x32_bf16 v[34:37], v[150:153], v[106:109], v[34:37]
    v_mfma_f32_16x16x32_bf16 v[30:33], v[78:81], v[82:85], v[30:33]
    v_mfma_f32_16x16x32_bf16 v[30:33], v[110:113], v[154:157], v[30:33]
    v_mfma_f32_16x16x32_bf16 v[34:37], v[102:105], v[82:85], v[34:37]
    v_mfma_f32_16x16x32_bf16 v[34:37], v[110:113], v[50:53], v[34:37]
    s_waitcnt lgkmcnt(4)
    s_nop 0
    v_mfma_f32_16x16x32_bf16 v[30:33], v[86:89], v[146:149], v[30:33]
    s_waitcnt lgkmcnt(2)
    s_nop 0
    v_mfma_f32_16x16x32_bf16 v[30:33], v[158:161], v[114:117], v[30:33]
    v_mfma_f32_16x16x32_bf16 v[34:37], v[78:81], v[146:149], v[34:37]
    v_mfma_f32_16x16x32_bf16 v[34:37], v[158:161], v[154:157], v[34:37]
    s_waitcnt lgkmcnt(1)
    s_nop 0
    v_mfma_f32_16x16x32_bf16 v[34:37], v[86:89], v[98:101], v[34:37]
    s_waitcnt lgkmcnt(0)
    s_nop 0
    v_mfma_f32_16x16x32_bf16 v[34:37], v[70:73], v[114:117], v[34:37]
    s_nop 7
    v_cvt_pk_bf16_f32 v30, v30, v31
    v_cvt_pk_bf16_f32 v31, v32, v33
    ds_write_b64 v4, v[30:31] offset:3456
    v_cvt_pk_bf16_f32 v34, v34, v35
    v_cvt_pk_bf16_f32 v35, v36, v37
    ds_write_b64 v4, v[34:35] offset:4032
    ds_write_b32 v5, v5 offset:32
    s_endpgm
L_kgen:
    s_lshr_b32 s92, s100, 1
    s_and_b32 s93, s100, 1
    s_add_u32 s9, s6, s92
    s_lshl_b32 s11, s9, 1
    v_mov_b32 v8, s11
    s_lshl_b32 s9, s9, 8
    s_lshl_b32 s10, s93, 7
    s_add_u32 s9, s9, s10
    v_lshl_add_u32 v2, v1, 1, s9
    s_waitcnt lgkmcnt(0)
    global_load_ushort v7, v8, s[26:27]
    global_load_ushort v3, v2, s[18:19] nt
    global_load_ushort v4, v2, s[20:21] nt
    global_load_ushort v5, v2, s[22:23] nt
    global_load_ushort v6, v2, s[24:25] nt
    s_lshr_b32 s92, s100, 1
    s_and_b32 s93, s100, 1
    s_lshl_b32 s8, s93, 7
    s_add_u32 s8, s8, 0
    v_add_u32 v12, s8, v1
    s_mul_i32 s9, s92, 6208
    s_add_u32 s9, s9, 103744
    s_sub_u32 s11, s9, 136192
    s_mul_i32 s10, s92, 25936
    s_add_u32 s10, s10, 12
    v_lshlrev_b32 v11, 3, v12
    v_sub_u32 v11, 2047, v11
    v_cvt_f32_u32 v8, v11
    v_cvt_pk_bf16_f32 v154, 0, v8
    v_lshrrev_b32 v154, 13, v154
    v_add_u32 v154, s11, v154
    v_add_f32 v9, -1.0, v8
    v_cvt_pk_bf16_f32 v155, 0, v9
    v_lshrrev_b32 v155, 13, v155
    v_add_u32 v155, s11, v155
    v_add_f32 v9, -2.0, v8
    v_cvt_pk_bf16_f32 v156, 0, v9
    v_lshrrev_b32 v156, 13, v156
    v_add_u32 v156, s11, v156
    v_add_f32 v9, 0xc0400000, v8
    v_cvt_pk_bf16_f32 v157, 0, v9
    v_lshrrev_b32 v157, 13, v157
    v_add_u32 v157, s11, v157
    v_add_f32 v9, -4.0, v8
    v_cvt_pk_bf16_f32 v158, 0, v9
    v_lshrrev_b32 v158, 13, v158
    v_add_u32 v158, s11, v158
    v_add_f32 v9, 0xc0a00000, v8
    v_cvt_pk_bf16_f32 v159, 0, v9
    v_lshrrev_b32 v159, 13, v159
    v_add_u32 v159, s11, v159
    v_add_f32 v9, 0xc0c00000, v8
    v_cvt_pk_bf16_f32 v160, 0, v9
    v_lshrrev_b32 v160, 13, v160
    v_add_u32 v160, s11, v160
    v_add_f32 v9, 0xc0e00000, v8
    v_cvt_pk_bf16_f32 v161, 0, v9
    v_lshrrev_b32 v161, 13, v161
    v_add_u32 v161, s11, v161
    v_add_f32 v9, 0xc1000000, v8
    v_cvt_pk_bf16_f32 v162, 0, v9
    v_lshrrev_b32 v162, 13, v162
    v_add_u32 v162, s11, v162
    v_lshl_add_u32 v163, v12, 4, s10
    s_lshl_b32 s8, s92, 2
    s_add_u32 s8, s8, 134608
    v_mov_b32 v164, s8
    s_mul_i32 s8, s100, 4608
    s_add_u32 s8, s8, 116160
    v_lshl_add_u32 v16, v1, 2, s8
    v_and_b32 v13, 15, v1
    v_lshrrev_b32 v8, 4, v1
    v_mul_u32_u24 v17, 288, v13
    v_lshl_add_u32 v17, v8, 4, v17
    v_add_u32 v17, s8, v17
    s_lshl_b32 s8, s93, 2
    s_add_u32 s9, s9, s8
    v_lshrrev_b32 v9, 1, v8
    v_and_b32 v10, 1, v8
    v_lshlrev_b32 v18, 7, v9
    v_lshl_add_u32 v18, v10, 2, v18
    v_lshl_add_u32 v18, v13, 3, v18
    v_lshl_add_u32 v18, v18, 3, s9
    v_lshlrev_b32 v11, 1, v10
    v_lshl_add_u32 v11, v13, 2, v11
    v_add_u32 v11, 0x100, v11
    v_lshlrev_b32 v12, 5, v10
    v_lshl_add_u32 v12, v13, 1, v12
    v_cmp_eq_u32 vcc, 0, v9
    v_add_u32 v12, 0x180, v12
    v_lshl_add_u32 v49, v8, 6, v13
    v_cndmask_b32 v19, v12, v11, vcc
    v_lshl_add_u32 v19, v19, 3, s9
    v_add_u32 v49, 0x200, v49
    v_lshl_add_u32 v49, v49, 3, s9
    s_barrier
    s_waitcnt vmcnt(0)
    v_lshlrev_b32 v8, 16, v7
    v_lshlrev_b32 v9, 16, v3
    s_mov_b32 s9, 0x3fb8aa3b
    s_mov_b32 s10, 0x32a57060
    v_mul_f32 v10, s9, v8
    v_fma_f32 v12, v8, s9, -v10
    v_fma_f32 v12, v8, s10, v12
    v_exp_f32 v10, v10
    v_mul_f32 v12, 0x3f317218, v12
    v_mul_f32 v11, s9, v9
    v_fma_f32 v13, v9, s9, -v11
    v_fma_f32 v13, v9, s10, v13
    v_exp_f32 v11, v11
    v_mul_f32 v13, 0x3f317218, v13
    v_lshlrev_b32 v4, 16, v4
    v_fma_f32 v10, v10, v12, v10
    v_cvt_pk_bf16_f32 v10, 0, v10
    v_fma_f32 v11, v11, v13, v11
    v_cvt_pk_bf16_f32 v11, 0, v11
    v_mul_f32 v11, v11, v10
    v_mul_f32 v11, 0xbfb8aa3b, v11
    v_mul_f32 v4, v4, v10
    v_mul_f32 v12, 0.15915494, v4
    v_add_f32 v10, v10, v10
    v_lshlrev_b32 v5, 16, v5
    v_lshlrev_b32 v6, 16, v6
    v_mul_f32 v14, v5, v10
    v_mul_f32 v15, v6, v10
    v_max_f32 v13, |v14|, |v15|
    v_exp_f32 v50, v11
    v_fract_f32 v51, v12
    v_max_u32_dpp v13, v13, v13 quad_perm:[1,0,3,2] row_mask:0xf bank_mask:0xf
    v_mul_f32 v52, 0x41000000, v11
    v_mul_f32 v53, 0x41000000, v12
    v_max_u32_dpp v13, v13, v13 quad_perm:[2,3,0,1] row_mask:0xf bank_mask:0xf
    v_exp_f32 v52, v52
    v_fract_f32 v53, v53
    v_max_u32_dpp v13, v13, v13 row_half_mirror row_mask:0xf bank_mask:0xf
    v_mul_f32 v54, 0x43000000, v11
    v_mul_f32 v55, 0x43000000, v12
    v_max_u32_dpp v13, v13, v13 row_mirror row_mask:0xf bank_mask:0xf
    v_exp_f32 v54, v54
    v_fract_f32 v55, v55
    v_max_u32_dpp v13, v13, v13 row_bcast:15 row_mask:0xa bank_mask:0xf
    v_cos_f32 v20, v51
    v_sin_f32 v21, v51
    v_max_u32_dpp v13, v13, v13 row_bcast:31 row_mask:0xc bank_mask:0xf
    v_cos_f32 v26, v53
    v_sin_f32 v27, v53
    v_cos_f32 v34, v55
    v_sin_f32 v35, v55
    v_readlane_b32 s8, v13, 63
    v_mul_f32 v20, v20, v50
    v_mul_f32 v21, v21, v50
    v_mul_f32 v26, v26, v52
    v_mul_f32 v27, v27, v52
    v_mul_f32 v34, v34, v54
    v_mul_f32 v35, v35, v54
    s_lshr_b32 s8, s8, 23
    s_max_u32 s8, s8, 16
    s_sub_u32 s89, 264, s8
    s_lshl_b32 s89, s89, 23
    s_sub_u32 s90, s8, 10
    s_lshl_b32 s90, s90, 23
    v_pk_mul_f32 v[28:29], v[26:27], v[26:27] op_sel:[0,0] op_sel_hi:[1,0]
    v_pk_mul_f32 v[36:37], v[34:35], v[34:35] op_sel:[0,0] op_sel_hi:[1,0]
    v_pk_mul_f32 v[22:23], v[20:21], v[20:21] op_sel:[0,0] op_sel_hi:[1,0]
    v_fma_f32 v28, -v27, v27, v28
    v_fma_f32 v36, -v35, v35, v36
    v_fma_f32 v22, -v21, v21, v22
    v_fmac_f32 v29, v26, v27
    v_fmac_f32 v37, v34, v35
    v_fmac_f32 v23, v20, v21
    v_pk_mul_f32 v[30:31], v[28:29], v[28:29] op_sel:[0,0] op_sel_hi:[1,0]
    v_pk_mul_f32 v[38:39], v[36:37], v[36:37] op_sel:[0,0] op_sel_hi:[1,0]
    v_pk_mul_f32 v[24:25], v[22:23], v[22:23] op_sel:[0,0] op_sel_hi:[1,0]
    v_fma_f32 v30, -v29, v29, v30
    v_fma_f32 v38, -v37, v37, v38
    v_fma_f32 v24, -v23, v23, v24
    v_fmac_f32 v31, v28, v29
    v_fmac_f32 v39, v36, v37
    v_fmac_f32 v25, v22, v23
    v_pk_mul_f32 v[32:33], v[30:31], v[30:31] op_sel:[0,0] op_sel_hi:[1,0]
    v_pk_mul_f32 v[40:41], v[38:39], v[38:39] op_sel:[0,0] op_sel_hi:[1,0]
    v_fma_f32 v32, -v31, v31, v32
    v_fma_f32 v40, -v39, v39, v40
    v_fmac_f32 v33, v30, v31
    v_fmac_f32 v41, v38, v39
    v_pk_mul_f32 v[42:43], v[40:41], v[40:41] op_sel:[0,0] op_sel_hi:[1,0]
    v_fma_f32 v42, -v41, v41, v42
    v_fmac_f32 v43, v40, v41
    v_mov_b32 v48, 0x3c00
    ds_write_b32 v16, v48
    v_pk_mul_f32 v[56:57], v[28:29], v[26:27] op_sel:[0,0] op_sel_hi:[1,0]
    v_cvt_pk_f16_f32 v45, v26, -v27
    v_fma_f32 v56, -v29, v27, v56
    ds_write_b32 v16, v45 offset:288
    v_fmac_f32 v57, v28, v27
    v_cvt_pk_f16_f32 v44, v56, -v57
    ds_write_b32 v16, v44 offset:864
    v_pk_mul_f32 v[58:59], v[30:31], v[26:27] op_sel:[0,0] op_sel_hi:[1,0]
    v_cvt_pk_f16_f32 v47, v28, -v29
    v_fma_f32 v58, -v31, v27, v58
    ds_write_b32 v16, v47 offset:576
    v_fmac_f32 v59, v30, v27
    v_cvt_pk_f16_f32 v46, v58, -v59
    ds_write_b32 v16, v46 offset:1440
    v_pk_mul_f32 v[60:61], v[30:31], v[28:29] op_sel:[0,0] op_sel_hi:[1,0]
    v_cvt_pk_f16_f32 v45, v30, -v31
    v_fma_f32 v60, -v31, v29, v60
    ds_write_b32 v16, v45 offset:1152
    v_fmac_f32 v61, v30, v29
    v_cvt_pk_f16_f32 v44, v60, -v61
    ds_write_b32 v16, v44 offset:1728
    v_pk_mul_f32 v[62:63], v[30:31], v[56:57] op_sel:[0,0] op_sel_hi:[1,0]
    v_cvt_pk_f16_f32 v47, v32, -v33
    v_fma_f32 v62, -v31, v57, v62
    ds_write_b32 v16, v47 offset:2304
    v_fmac_f32 v63, v30, v57
    v_cvt_pk_f16_f32 v46, v62, -v63
    ds_write_b32 v16, v46 offset:2016
    v_pk_mul_f32 v[100:101], v[32:33], v[26:27] op_sel:[0,0] op_sel_hi:[1,0]
    v_pk_mul_f32 v[102:103], v[32:33], v[28:29] op_sel:[0,0] op_sel_hi:[1,0]
    v_fma_f32 v100, -v33, v27, v100
    v_fma_f32 v102, -v33, v29, v102
    v_fmac_f32 v101, v32, v27
    v_fmac_f32 v103, v32, v29
    v_cvt_pk_f16_f32 v44, v100, -v101
    v_cvt_pk_f16_f32 v45, v102, -v103
    ds_write_b32 v16, v44 offset:2592
    ds_write_b32 v16, v45 offset:2880
    v_pk_mul_f32 v[104:105], v[32:33], v[56:57] op_sel:[0,0] op_sel_hi:[1,0]
    v_pk_mul_f32 v[98:99], v[32:33], v[30:31] op_sel:[0,0] op_sel_hi:[1,0]
    v_fma_f32 v104, -v33, v57, v104
    v_fma_f32 v98, -v33, v31, v98
    v_fmac_f32 v105, v32, v57
    v_fmac_f32 v99, v32, v31
    v_cvt_pk_f16_f32 v46, v104, -v105
    v_cvt_pk_f16_f32 v47, v98, -v99
    ds_write_b32 v16, v46 offset:3168
    ds_write_b32 v16, v47 offset:3456
    v_pk_mul_f32 v[100:101], v[32:33], v[58:59] op_sel:[0,0] op_sel_hi:[1,0]
    v_pk_mul_f32 v[102:103], v[32:33], v[60:61] op_sel:[0,0] op_sel_hi:[1,0]
    v_fma_f32 v100, -v33, v59, v100
    v_fma_f32 v102, -v33, v61, v102
    v_fmac_f32 v101, v32, v59
    v_fmac_f32 v103, v32, v61
    v_cvt_pk_f16_f32 v44, v100, -v101
    v_cvt_pk_f16_f32 v45, v102, -v103
    ds_write_b32 v16, v44 offset:3744
    ds_write_b32 v16, v45 offset:4032
    v_pk_mul_f32 v[104:105], v[32:33], v[62:63] op_sel:[0,0] op_sel_hi:[1,0]
    v_fma_f32 v104, -v33, v63, v104
    v_fmac_f32 v105, v32, v63
    v_cvt_pk_f16_f32 v46, v104, -v105
    ds_write_b32 v16, v46 offset:4320
    ds_read_b128 v[106:109], v17 offset:0
    ds_read_b128 v[110:113], v17 offset:64
    ds_read_b128 v[114:117], v17 offset:128
    ds_read_b128 v[118:121], v17 offset:192
    v_mul_f32 v64, s89, v14
    v_mul_f32 v65, s89, v15
    v_pk_mul_f32 v[56:57], v[22:23], v[20:21] op_sel:[0,0] op_sel_hi:[1,0]
    v_pk_mul_f32 v[66:67], v[64:65], v[34:35] op_sel:[0,0] op_sel_hi:[1,0]
    v_fma_f32 v56, -v23, v21, v56
    v_fma_f32 v66, -v65, v35, v66
    v_fmac_f32 v57, v22, v21
    v_fmac_f32 v67, v64, v35
    v_pk_mul_f32 v[58:59], v[24:25], v[20:21] op_sel:[0,0] op_sel_hi:[1,0]
    v_pk_mul_f32 v[60:61], v[24:25], v[22:23] op_sel:[0,0] op_sel_hi:[1,0]
    v_fma_f32 v58, -v25, v21, v58
    v_fma_f32 v60, -v25, v23, v60
    v_fmac_f32 v59, v24, v21
    v_fmac_f32 v61, v24, v23
    v_pk_mul_f32 v[62:63], v[24:25], v[56:57] op_sel:[0,0] op_sel_hi:[1,0]
    v_pk_mul_f32 v[68:69], v[64:65], v[36:37] op_sel:[0,0] op_sel_hi:[1,0]
    v_fma_f32 v62, -v25, v57, v62
    v_fma_f32 v68, -v65, v37, v68
    v_fmac_f32 v63, v24, v57
    v_fmac_f32 v69, v64, v37
    v_cvt_pk_f16_f32 v47, v64, v65
    v_cvt_pk_f16_f32 v44, v66, v67
    ds_write_b32 v16, v47 offset:0
    ds_write_b32 v16, v44 offset:2304
    v_pk_mul_f32 v[98:99], v[64:65], v[20:21] op_sel:[0,0] op_sel_hi:[1,0]
    v_pk_mul_f32 v[100:101], v[66:67], v[20:21] op_sel:[0,0] op_sel_hi:[1,0]
    v_fma_f32 v98, -v65, v21, v98
    v_fma_f32 v100, -v67, v21, v100
    v_fmac_f32 v99, v64, v21
    v_fmac_f32 v101, v66, v21
    v_cvt_pk_f16_f32 v45, v98, v99
    v_cvt_pk_f16_f32 v46, v100, v101
    ds_write_b32 v16, v45 offset:288
    ds_write_b32 v16, v46 offset:2592
    v_pk_mul_f32 v[102:103], v[64:65], v[22:23] op_sel:[0,0] op_sel_hi:[1,0]
    v_pk_mul_f32 v[104:105], v[66:67], v[22:23] op_sel:[0,0] op_sel_hi:[1,0]
    v_fma_f32 v102, -v65, v23, v102
    v_fma_f32 v104, -v67, v23, v104
    v_fmac_f32 v103, v64, v23
    v_fmac_f32 v105, v66, v23
    v_cvt_pk_f16_f32 v47, v102, v103
    v_cvt_pk_f16_f32 v44, v104, v105
    ds_write_b32 v16, v47 offset:576
    ds_write_b32 v16, v44 offset:2880
    v_pk_mul_f32 v[98:99], v[64:65], v[56:57] op_sel:[0,0] op_sel_hi:[1,0]
    v_pk_mul_f32 v[100:101], v[66:67], v[56:57] op_sel:[0,0] op_sel_hi:[1,0]
    v_fma_f32 v98, -v65, v57, v98
    v_fma_f32 v100, -v67, v57, v100
    v_fmac_f32 v99, v64, v57
    v_fmac_f32 v101, v66, v57
    v_cvt_pk_f16_f32 v45, v98, v99
    v_cvt_pk_f16_f32 v46, v100, v101
    ds_write_b32 v16, v45 offset:864
    ds_write_b32 v16, v46 offset:3168
    v_pk_mul_f32 v[102:103], v[64:65], v[24:25] op_sel:[0,0] op_sel_hi:[1,0]
    v_pk_mul_f32 v[104:105], v[66:67], v[24:25] op_sel:[0,0] op_sel_hi:[1,0]
    v_fma_f32 v102, -v65, v25, v102
    v_fma_f32 v104, -v67, v25, v104
    v_fmac_f32 v103, v64, v25
    v_fmac_f32 v105, v66, v25
    v_cvt_pk_f16_f32 v47, v102, v103
    v_cvt_pk_f16_f32 v44, v104, v105
    ds_write_b32 v16, v47 offset:1152
    ds_write_b32 v16, v44 offset:3456
    v_pk_mul_f32 v[98:99], v[64:65], v[58:59] op_sel:[0,0] op_sel_hi:[1,0]
    v_pk_mul_f32 v[100:101], v[66:67], v[58:59] op_sel:[0,0] op_sel_hi:[1,0]
    v_fma_f32 v98, -v65, v59, v98
    v_fma_f32 v100, -v67, v59, v100
    v_fmac_f32 v99, v64, v59
    v_fmac_f32 v101, v66, v59
    v_cvt_pk_f16_f32 v45, v98, v99
    v_cvt_pk_f16_f32 v46, v100, v101
    ds_write_b32 v16, v45 offset:1440
    ds_write_b32 v16, v46 offset:3744
    v_pk_mul_f32 v[102:103], v[64:65], v[60:61] op_sel:[0,0] op_sel_hi:[1,0]
    v_pk_mul_f32 v[104:105], v[66:67], v[60:61] op_sel:[0,0] op_sel_hi:[1,0]
    v_fma_f32 v102, -v65, v61, v102
    v_fma_f32 v104, -v67, v61, v104
    v_fmac_f32 v103, v64, v61
    v_fmac_f32 v105, v66, v61
    v_cvt_pk_f16_f32 v47, v102, v103
    v_cvt_pk_f16_f32 v44, v104, v105
    ds_write_b32 v16, v47 offset:1728
    ds_write_b32 v16, v44 offset:4032
    v_pk_mul_f32 v[98:99], v[64:65], v[62:63] op_sel:[0,0] op_sel_hi:[1,0]
    v_pk_mul_f32 v[100:101], v[66:67], v[62:63] op_sel:[0,0] op_sel_hi:[1,0]
    v_fma_f32 v98, -v65, v63, v98
    v_fma_f32 v100, -v67, v63, v100
    v_fmac_f32 v99, v64, v63
    v_fmac_f32 v101, v66, v63
    v_cvt_pk_f16_f32 v45, v98, v99
    v_cvt_pk_f16_f32 v46, v100, v101
    ds_write_b32 v16, v45 offset:2016
    ds_write_b32 v16, v46 offset:4320
    ds_read_b128 v[122:125], v17 offset:0
    ds_read_b128 v[126:129], v17 offset:64
    ds_read_b128 v[130:133], v17 offset:128
    ds_read_b128 v[134:137], v17 offset:192
    v_pk_mul_f32 v[70:71], v[66:67], v[36:37] op_sel:[0,0] op_sel_hi:[1,0]
    v_pk_mul_f32 v[72:73], v[64:65], v[38:39] op_sel:[0,0] op_sel_hi:[1,0]
    v_fma_f32 v70, -v67, v37, v70
    v_fma_f32 v72, -v65, v39, v72
    v_fmac_f32 v71, v66, v37
    v_fmac_f32 v73, v64, v39
    v_pk_mul_f32 v[74:75], v[66:67], v[38:39] op_sel:[0,0] op_sel_hi:[1,0]
    v_pk_mul_f32 v[76:77], v[68:69], v[38:39] op_sel:[0,0] op_sel_hi:[1,0]
    v_fma_f32 v74, -v67, v39, v74
    v_fma_f32 v76, -v69, v39, v76
    v_fmac_f32 v75, v66, v39
    v_fmac_f32 v77, v68, v39
    v_pk_mul_f32 v[78:79], v[70:71], v[38:39] op_sel:[0,0] op_sel_hi:[1,0]
    v_fma_f32 v78, -v71, v39, v78
    v_fmac_f32 v79, v70, v39
    v_cvt_pk_f16_f32 v47, v68, v69
    v_pk_mul_f32 v[102:103], v[68:69], v[22:23] op_sel:[0,0] op_sel_hi:[1,0]
    ds_write_b32 v16, v47 offset:0
    v_fma_f32 v102, -v69, v23, v102
    v_fmac_f32 v103, v68, v23
    v_cvt_pk_f16_f32 v44, v102, v103
    ds_write_b32 v16, v44 offset:288
    v_cvt_pk_f16_f32 v45, v70, v71
    v_pk_mul_f32 v[104:105], v[70:71], v[22:23] op_sel:[0,0] op_sel_hi:[1,0]
    ds_write_b32 v16, v45 offset:576
    v_fma_f32 v104, -v71, v23, v104
    v_fmac_f32 v105, v70, v23
    v_cvt_pk_f16_f32 v46, v104, v105
    ds_write_b32 v16, v46 offset:864
    v_pk_mul_f32 v[98:99], v[68:69], v[24:25] op_sel:[0,0] op_sel_hi:[1,0]
    v_pk_mul_f32 v[100:101], v[68:69], v[60:61] op_sel:[0,0] op_sel_hi:[1,0]
    v_fma_f32 v98, -v69, v25, v98
    v_fma_f32 v100, -v69, v61, v100
    v_fmac_f32 v99, v68, v25
    v_fmac_f32 v101, v68, v61
    v_cvt_pk_f16_f32 v47, v98, v99
    v_cvt_pk_f16_f32 v44, v100, v101
    ds_write_b32 v16, v47 offset:1152
    ds_write_b32 v16, v44 offset:1440
    v_pk_mul_f32 v[102:103], v[70:71], v[24:25] op_sel:[0,0] op_sel_hi:[1,0]
    v_pk_mul_f32 v[104:105], v[70:71], v[60:61] op_sel:[0,0] op_sel_hi:[1,0]
    v_fma_f32 v102, -v71, v25, v102
    v_fma_f32 v104, -v71, v61, v104
    v_fmac_f32 v103, v70, v25
    v_fmac_f32 v105, v70, v61
    v_cvt_pk_f16_f32 v45, v102, v103
    v_cvt_pk_f16_f32 v46, v104, v105
    ds_write_b32 v16, v45 offset:1728
    ds_write_b32 v16, v46 offset:2016
    v_cvt_pk_f16_f32 v47, v72, v73
    v_pk_mul_f32 v[98:99], v[72:73], v[24:25] op_sel:[0,0] op_sel_hi:[1,0]
    ds_write_b32 v16, v47 offset:2304
    v_fma_f32 v98, -v73, v25, v98
    v_fmac_f32 v99, v72, v25
    v_cvt_pk_f16_f32 v44, v98, v99
    ds_write_b32 v16, v44 offset:2592
    v_cvt_pk_f16_f32 v45, v76, v77
    v_pk_mul_f32 v[100:101], v[76:77], v[24:25] op_sel:[0,0] op_sel_hi:[1,0]
    ds_write_b32 v16, v45 offset:2880
    v_fma_f32 v100, -v77, v25, v100
    v_fmac_f32 v101, v76, v25
    v_cvt_pk_f16_f32 v46, v100, v101
    ds_write_b32 v16, v46 offset:3168
    v_cvt_pk_f16_f32 v47, v74, v75
    v_pk_mul_f32 v[102:103], v[74:75], v[24:25] op_sel:[0,0] op_sel_hi:[1,0]
    ds_write_b32 v16, v47 offset:3456
    v_fma_f32 v102, -v75, v25, v102
    v_fmac_f32 v103, v74, v25
    v_cvt_pk_f16_f32 v44, v102, v103
    ds_write_b32 v16, v44 offset:3744
    v_cvt_pk_f16_f32 v45, v78, v79
    v_pk_mul_f32 v[104:105], v[78:79], v[24:25] op_sel:[0,0] op_sel_hi:[1,0]
    ds_write_b32 v16, v45 offset:4032
    v_fma_f32 v104, -v79, v25, v104
    v_fmac_f32 v105, v78, v25
    v_cvt_pk_f16_f32 v46, v104, v105
    ds_write_b32 v16, v46 offset:4320
    ds_read_b128 v[138:141], v17 offset:0
    ds_read_b128 v[142:145], v17 offset:64
    ds_read_b128 v[146:149], v17 offset:128
    ds_read_b128 v[150:153], v17 offset:192
    v_pk_mul_f32 v[80:81], v[64:65], v[40:41] op_sel:[0,0] op_sel_hi:[1,0]
    v_pk_mul_f32 v[82:83], v[66:67], v[40:41] op_sel:[0,0] op_sel_hi:[1,0]
    v_fma_f32 v80, -v65, v41, v80
    v_fma_f32 v82, -v67, v41, v82
    v_fmac_f32 v81, v64, v41
    v_fmac_f32 v83, v66, v41
    v_cvt_pk_f16_f32 v47, v80, v81
    v_cvt_pk_f16_f32 v44, v82, v83
    ds_write_b32 v16, v47 offset:0
    ds_write_b32 v16, v44 offset:288
    v_pk_mul_f32 v[84:85], v[68:69], v[40:41] op_sel:[0,0] op_sel_hi:[1,0]
    v_pk_mul_f32 v[86:87], v[70:71], v[40:41] op_sel:[0,0] op_sel_hi:[1,0]
    v_fma_f32 v84, -v69, v41, v84
    v_fma_f32 v86, -v71, v41, v86
    v_fmac_f32 v85, v68, v41
    v_fmac_f32 v87, v70, v41
    v_cvt_pk_f16_f32 v45, v84, v85
    v_cvt_pk_f16_f32 v46, v86, v87
    ds_write_b32 v16, v45 offset:576
    ds_write_b32 v16, v46 offset:864
    v_pk_mul_f32 v[88:89], v[72:73], v[40:41] op_sel:[0,0] op_sel_hi:[1,0]
    v_pk_mul_f32 v[90:91], v[74:75], v[40:41] op_sel:[0,0] op_sel_hi:[1,0]
    v_fma_f32 v88, -v73, v41, v88
    v_fma_f32 v90, -v75, v41, v90
    v_fmac_f32 v89, v72, v41
    v_fmac_f32 v91, v74, v41
    v_cvt_pk_f16_f32 v47, v88, v89
    v_cvt_pk_f16_f32 v44, v90, v91
    ds_write_b32 v16, v47 offset:1152
    ds_write_b32 v16, v44 offset:1440
    v_pk_mul_f32 v[92:93], v[76:77], v[40:41] op_sel:[0,0] op_sel_hi:[1,0]
    v_pk_mul_f32 v[94:95], v[78:79], v[40:41] op_sel:[0,0] op_sel_hi:[1,0]
    v_fma_f32 v92, -v77, v41, v92
    v_fma_f32 v94, -v79, v41, v94
    v_fmac_f32 v93, v76, v41
    v_fmac_f32 v95, v78, v41
    v_cvt_pk_f16_f32 v45, v92, v93
    v_cvt_pk_f16_f32 v46, v94, v95
    ds_write_b32 v16, v45 offset:1728
    ds_write_b32 v16, v46 offset:2016
    v_pk_mul_f32 v[96:97], v[64:65], v[42:43] op_sel:[0,0] op_sel_hi:[1,0]
    v_fma_f32 v96, -v65, v43, v96
    v_fmac_f32 v97, v64, v43
    v_cvt_pk_f16_f32 v47, v96, v97
    ds_write_b32 v16, v47 offset:2304
    ds_read_b128 v[20:23], v17 offset:0
    ds_read_b128 v[24:27], v17 offset:64
    ds_read_b128 v[28:31], v17 offset:128
    ds_read_b128 v[32:35], v17 offset:192
    s_waitcnt lgkmcnt(4)
    v_mfma_f32_16x16x32_f16 v[36:39], v[122:125], v[106:109], 0
    v_mfma_f32_16x16x32_f16 v[36:39], v[126:129], v[110:113], v[36:39]
    v_mfma_f32_16x16x32_f16 v[36:39], v[130:133], v[114:117], v[36:39]
    v_mfma_f32_16x16x32_f16 v[36:39], v[134:137], v[118:121], v[36:39]
    v_mfma_f32_16x16x32_f16 v[40:43], v[138:141], v[106:109], 0
    v_mfma_f32_16x16x32_f16 v[40:43], v[142:145], v[110:113], v[40:43]
    v_mfma_f32_16x16x32_f16 v[40:43], v[146:149], v[114:117], v[40:43]
    v_mfma_f32_16x16x32_f16 v[40:43], v[150:153], v[118:121], v[40:43]
    s_waitcnt lgkmcnt(0)
    v_mfma_f32_16x16x32_f16 v[44:47], v[20:23], v[106:109], 0
    v_mfma_f32_16x16x32_f16 v[44:47], v[24:27], v[110:113], v[44:47]
    v_mfma_f32_16x16x32_f16 v[44:47], v[28:31], v[114:117], v[44:47]
    v_mfma_f32_16x16x32_f16 v[44:47], v[32:35], v[118:121], v[44:47]
    v_mov_b32 v8, 1
    s_nop 2
    v_mul_f32 v36, s90, v36
    v_mul_f32 v37, s90, v37
    v_mul_f32 v38, s90, v38
    v_mul_f32 v39, s90, v39
    v_mul_f32 v40, s90, v40
    v_mul_f32 v41, s90, v41
    v_mul_f32 v42, s90, v42
    v_mul_f32 v43, s90, v43
    ds_write_b32 v18, v36 offset:0
    ds_write_b32 v18, v37 offset:8
    ds_write_b32 v18, v38 offset:16
    ds_write_b32 v18, v39 offset:24
    ds_write_b32 v19, v40 offset:0
    ds_write_b32 v19, v41 offset:8
    ds_write_b32 v19, v42 offset:512
    ds_write_b32 v19, v43 offset:520
    v_mul_f32 v44, s90, v44
    v_mul_f32 v45, s90, v45
    v_mul_f32 v46, s90, v46
    v_mul_f32 v47, s90, v47
    ds_write_b32 v49, v44 offset:0
    ds_write_b32 v49, v45 offset:128
    ds_write_b32 v49, v46 offset:256
    ds_write_b32 v49, v47 offset:384
    s_mov_b64 exec, 1
    ds_add_u32 v164, v8
    s_mov_b64 exec, -1
    s_mov_b32 s91, 0
L_kspin_k:
    ds_read_b32 v8, v164
    s_add_u32 s91, s91, 1
    s_waitcnt lgkmcnt(0)
    v_readfirstlane_b32 s8, v8
    s_cmp_ge_u32 s91, 0x200000
    s_cbranch_scc1 L_kspin_k_done
    s_cmp_ge_u32 s8, 2
    s_cbranch_scc1 L_kspin_k_done
    s_branch L_kspin_k
L_kspin_k_done:
    ds_read_b64 v[100:101], v154
    ds_read_b64 v[102:103], v155
    ds_read_b64 v[104:105], v156
    ds_read_b64 v[106:107], v157
    ds_read_b64 v[108:109], v158
    ds_read_b64 v[110:111], v159
    ds_read_b64 v[112:113], v160
    ds_read_b64 v[114:115], v161
    ds_read_b64 v[116:117], v162
    s_waitcnt lgkmcnt(0)
    v_add_f32 v100, v100, v101
    v_add_f32 v102, v102, v103
    v_add_f32 v104, v104, v105
    v_add_f32 v106, v106, v107
    v_add_f32 v108, v108, v109
    v_add_f32 v110, v110, v111
    v_add_f32 v112, v112, v113
    v_add_f32 v114, v114, v115
    v_add_f32 v116, v116, v117
    v_cvt_pk_bf16_f32 v120, v100, v102
    v_cvt_pk_bf16_f32 v124, v102, v104
    v_cvt_pk_bf16_f32 v121, v104, v106
    v_cvt_pk_bf16_f32 v125, v106, v108
    v_cvt_pk_bf16_f32 v122, v108, v110
    v_cvt_pk_bf16_f32 v126, v110, v112
    v_cvt_pk_bf16_f32 v123, v112, v114
    v_cvt_pk_bf16_f32 v127, v114, v116
    ds_write_b128 v163, v[120:123] offset:12484
    ds_write_b128 v163, v[124:127] offset:8324
    ds_write2_b32 v163, v124, v125 offset0:0 offset1:1
    ds_write2_b32 v163, v126, v127 offset0:2 offset1:3
    v_add_u32 v163, 4160, v163
    ds_write2_b32 v163, v120, v121 offset0:0 offset1:1
    ds_write2_b32 v163, v122, v123 offset0:2 offset1:3
    s_waitcnt lgkmcnt(0)
    s_barrier
    s_endpgm
L_aux:
    v_mov_b32 v8, 0
    v_mov_b32 v9, 0
    v_mov_b32 v10, 0
    v_mov_b32 v11, 0
    v_lshrrev_b32 v12, 6, v0
    v_mul_u32_u24 v12, 25936, v12
    v_bfe_u32 v14, v0, 5, 1
    v_mul_u32_u24 v14, 4640, v14
    v_and_b32 v13, 31, v0
    v_min_u32 v13, 28, v13
    v_lshl_add_u32 v12, v13, 4, v12
    v_add_u32 v12, v12, v14
    ds_write_b128 v12, v[8:11] offset:16656
    v_bfe_u32 v13, v0, 4, 2
    v_mul_u32_u24 v13, 25936, v13
    v_bfe_u32 v14, v0, 2, 2
    v_mul_u32_u24 v14, 4160, v14
    v_and_b32 v15, 3, v0
    v_lshl_add_u32 v14, v15, 4, v14
    v_add_u32 v13, v13, v14
    v_add_u32 v13, 4096, v13
    v_cmp_gt_u32 vcc, 64, v0
    v_and_b32 v14, 15, v0
    v_lshlrev_b32 v14, 4, v14
    v_add_u32 v14, 134592, v14
    v_cndmask_b32 v12, v14, v13, vcc
    v_cmp_gt_u32 vcc, 0x80, v0
    v_and_b32 v15, 1, v0
    v_mul_u32_u24 v15, 6208, v15
    v_add_u32 v15, 109888, v15
    v_cndmask_b32 v12, v15, v12, vcc
    ds_write_b128 v12, v[8:11]
    s_waitcnt lgkmcnt(0)
    s_barrier
    s_mov_b32 s64, s48
    s_and_b32 s65, s49, 0xffff
    s_mov_b32 s66, 0x800000
    s_mov_b32 s67, 0x20000
    s_mov_b32 s72, s46
    s_and_b32 s73, s47, 0xffff
    s_mov_b32 s74, 0x100
    s_mov_b32 s75, 0x20000
    s_mov_b32 s68, s44
    s_and_b32 s69, s45, 0xffff
    s_mov_b32 s70, 0x200000
    s_mov_b32 s71, 0x20000
    s_lshr_b32 s92, s100, 1
    s_and_b32 s93, s100, 1
    s_lshl_b32 s8, s93, 7
    s_add_u32 s8, s8, 64
    v_add_u32 v12, s8, v1
    s_mul_i32 s9, s92, 6208
    s_add_u32 s9, s9, 103744
    s_sub_u32 s11, s9, 136192
    s_mul_i32 s10, s92, 25936
    s_add_u32 s10, s10, 12
    v_lshlrev_b32 v11, 3, v12
    v_sub_u32 v11, 2047, v11
    v_cvt_f32_u32 v8, v11
    v_cmp_gt_u32 vcc, 0x100, v11
    v_lshl_add_u32 v10, v11, 3, s9
    v_cvt_pk_bf16_f32 v154, 0, v8
    v_lshrrev_b32 v154, 13, v154
    v_add_u32 v154, s11, v154
    v_subrev_u32 v9, 0, v10
    v_cndmask_b32 v154, v154, v9, vcc
    v_add_f32 v9, -1.0, v8
    v_cvt_pk_bf16_f32 v155, 0, v9
    v_lshrrev_b32 v155, 13, v155
    v_add_u32 v155, s11, v155
    v_subrev_u32 v9, 8, v10
    v_cndmask_b32 v155, v155, v9, vcc
    v_add_f32 v9, -2.0, v8
    v_cvt_pk_bf16_f32 v156, 0, v9
    v_lshrrev_b32 v156, 13, v156
    v_add_u32 v156, s11, v156
    v_subrev_u32 v9, 16, v10
    v_cndmask_b32 v156, v156, v9, vcc
    v_add_f32 v9, 0xc0400000, v8
    v_cvt_pk_bf16_f32 v157, 0, v9
    v_lshrrev_b32 v157, 13, v157
    v_add_u32 v157, s11, v157
    v_subrev_u32 v9, 24, v10
    v_cndmask_b32 v157, v157, v9, vcc
    v_add_f32 v9, -4.0, v8
    v_cvt_pk_bf16_f32 v158, 0, v9
    v_lshrrev_b32 v158, 13, v158
    v_add_u32 v158, s11, v158
    v_subrev_u32 v9, 32, v10
    v_cndmask_b32 v158, v158, v9, vcc
    v_add_f32 v9, 0xc0a00000, v8
    v_cvt_pk_bf16_f32 v159, 0, v9
    v_lshrrev_b32 v159, 13, v159
    v_add_u32 v159, s11, v159
    v_subrev_u32 v9, 40, v10
    v_cndmask_b32 v159, v159, v9, vcc
    v_add_f32 v9, 0xc0c00000, v8
    v_cvt_pk_bf16_f32 v160, 0, v9
    v_lshrrev_b32 v160, 13, v160
    v_add_u32 v160, s11, v160
    v_subrev_u32 v9, 48, v10
    v_cndmask_b32 v160, v160, v9, vcc
    v_add_f32 v9, 0xc0e00000, v8
    v_cvt_pk_bf16_f32 v161, 0, v9
    v_lshrrev_b32 v161, 13, v161
    v_add_u32 v161, s11, v161
    v_subrev_u32 v9, 56, v10
    v_cndmask_b32 v161, v161, v9, vcc
    v_add_f32 v9, 0xc1000000, v8
    v_cvt_pk_bf16_f32 v162, 0, v9
    v_lshrrev_b32 v162, 13, v162
    v_add_u32 v162, s11, v162
    v_subrev_u32 v9, 64, v10
    v_cndmask_b32 v162, v162, v9, vcc
    v_lshl_add_u32 v163, v12, 4, s10
    v_cmp_eq_u32 vcc, 0xff, v12
    s_add_u32 s8, s9, 6144
    v_mov_b32 v9, s8
    v_cndmask_b32 v162, v162, v9, vcc
    s_lshl_b32 s8, s92, 2
    s_add_u32 s8, s8, 134608
    v_mov_b32 v164, s8
    s_lshl_b32 s8, s6, 12
    v_lshl_add_u32 v2, v0, 4, s8
    v_add_u32 v3, 0x1000, v2
    v_subrev_u32 v4, 4, v2
    v_max_i32 v4, s8, v4
    s_lshl_b32 s9, s99, 13
    s_lshl_b32 s10, s100, 11
    s_add_u32 s9, s9, s10
    v_lshlrev_b32 v6, 4, v1
    v_add_u32 v5, s9, v6
    s_lshl_b32 s8, s100, 4
    s_lshl_b32 s9, s99, 6
    s_add_u32 s8, s8, s9
    s_add_u32 s8, s8, 0x400000
    v_mov_b32 v7, s8
    v_mov_b32 v56, 0
    s_lshl_b32 s11, s6, 1
    v_lshlrev_b32 v8, 2, v0
    v_add_u32 v8, 0, v8
    v_lshlrev_b32 v128, 3, v8
    v_lshlrev_b32 v133, 1, v8
    v_add_u32 v138, 51872, v133
    v_lshrrev_b32 v9, 5, v8
    v_lshl_add_u32 v9, v9, 3, v133
    v_add_u32 v143, 134848, v9
    v_lshl_add_u32 v148, v8, 10, s11
    v_lshlrev_b32 v8, 1, v0
    v_add_u32 v8, 1024, v8
    v_lshlrev_b32 v129, 3, v8
    v_lshlrev_b32 v134, 1, v8
    v_add_u32 v139, 51872, v134
    v_lshrrev_b32 v9, 5, v8
    v_lshl_add_u32 v9, v9, 3, v134
    v_add_u32 v144, 134848, v9
    v_lshl_add_u32 v149, v8, 10, s11
    v_lshlrev_b32 v8, 1, v0
    v_add_u32 v8, 1536, v8
    v_lshlrev_b32 v130, 3, v8
    v_lshlrev_b32 v135, 1, v8
    v_add_u32 v140, 51872, v135
    v_lshrrev_b32 v9, 5, v8
    v_lshl_add_u32 v9, v9, 3, v135
    v_add_u32 v145, 134848, v9
    v_lshl_add_u32 v150, v8, 10, s11
    s_load_dword s86, s[28:29], s11
    s_load_dword s87, s[40:41], s11
    v_lshlrev_b32 v9, 4, v0
    v_sub_u32 v9, 4076, v9
    global_load_dwordx4 v[68:71], v2, s[38:39] nt
    global_load_dwordx4 v[74:77], v3, s[38:39] nt
    global_load_dword v67, v4, s[38:39] nt
    global_load_dword v73, v3, s[38:39] offset:-4 nt
    global_load_dwordx4 v[80:83], v5, s[16:17] nt
    global_load_dwordx4 v[84:87], v5, s[16:17] offset:1024 nt
    global_load_dwordx4 v[88:91], v6, s[42:43]
    buffer_load_dwordx2 v[52:53], v56, s[72:75], 0 offen sc1
    s_waitcnt lgkmcnt(0)
    s_lshl_b32 s82, s86, 16
    s_and_b32 s83, s86, s50
    s_lshl_b32 s84, s87, 16
    s_and_b32 s85, s87, s50
    s_waitcnt vmcnt(4)
    v_cmp_eq_u32 vcc, 0, v0
    s_nop 1
    v_cndmask_b32 v67, v67, 0, vcc
    v_alignbit_b32 v20, v71, v71, 16
    v_bfi_b32 v24, s51, v71, v70
    v_alignbit_b32 v21, v70, v70, 16
    v_bfi_b32 v25, s51, v70, v69
    v_alignbit_b32 v22, v69, v69, 16
    v_bfi_b32 v26, s51, v69, v68
    v_alignbit_b32 v23, v68, v68, 16
    v_bfi_b32 v27, s51, v68, v67
    v_add_u32 v36, 51888, v9
    ds_write_b128 v36, v[20:23] offset:12484
    ds_write_b128 v36, v[24:27] offset:8324
    ds_write2_b32 v36, v24, v25 offset0:0 offset1:1
    ds_write2_b32 v36, v26, v27 offset0:2 offset1:3
    v_add_u32 v36, 4160, v36
    ds_write2_b32 v36, v20, v21 offset0:0 offset1:1
    ds_write2_b32 v36, v22, v23 offset0:2 offset1:3
    v_cndmask_b32 v73, v73, 0, vcc
    v_alignbit_b32 v28, v77, v77, 16
    v_bfi_b32 v32, s51, v77, v76
    v_alignbit_b32 v29, v76, v76, 16
    v_bfi_b32 v33, s51, v76, v75
    v_alignbit_b32 v30, v75, v75, 16
    v_bfi_b32 v34, s51, v75, v74
    v_alignbit_b32 v31, v74, v74, 16
    v_bfi_b32 v35, s51, v74, v73
    v_add_u32 v37, 77824, v9
    ds_write_b128 v37, v[28:31] offset:12484
    ds_write_b128 v37, v[32:35] offset:8324
    ds_write2_b32 v37, v32, v33 offset0:0 offset1:1
    ds_write2_b32 v37, v34, v35 offset0:2 offset1:3
    v_add_u32 v37, 4160, v37
    ds_write2_b32 v37, v28, v29 offset0:0 offset1:1
    ds_write2_b32 v37, v30, v31 offset0:2 offset1:3
    s_mov_b32 s91, 0
    s_branch L_nchk_a
L_npoll_a:
    buffer_load_dwordx2 v[52:53], v56, s[72:75], 0 offen sc1
    s_add_u32 s91, s91, 1
L_nchk_a:
    s_waitcnt vmcnt(0)
    v_readfirstlane_b32 s14, v52
    v_readfirstlane_b32 s15, v53
    s_cmp_ge_u32 s91, 0x40000
    s_cbranch_scc1 L_npoll_done_a
    s_cmp_eq_u32 s14, 0
    s_cbranch_scc1 L_npoll_a
L_npoll_done_a:
    v_lshlrev_b32 v100, 16, v88
    v_and_b32 v101, s50, v88
    v_lshlrev_b32 v102, 16, v89
    v_and_b32 v103, s50, v89
    v_lshlrev_b32 v104, 16, v90
    v_and_b32 v105, s50, v90
    v_lshlrev_b32 v106, 16, v91
    v_and_b32 v107, s50, v91
    v_lshlrev_b32 v108, 16, v80
    v_and_b32 v109, s50, v80
    v_lshlrev_b32 v110, 16, v81
    v_and_b32 v111, s50, v81
    v_lshlrev_b32 v112, 16, v82
    v_and_b32 v113, s50, v82
    v_lshlrev_b32 v114, 16, v83
    v_and_b32 v115, s50, v83
    v_lshlrev_b32 v116, 16, v84
    v_and_b32 v117, s50, v84
    v_lshlrev_b32 v118, 16, v85
    v_and_b32 v119, s50, v85
    v_lshlrev_b32 v120, 16, v86
    v_and_b32 v121, s50, v86
    v_lshlrev_b32 v122, 16, v87
    v_and_b32 v123, s50, v87
    v_pk_mul_f32 v[108:109], v[108:109], v[100:101]
    v_pk_mul_f32 v[110:111], v[110:111], v[102:103]
    v_pk_mul_f32 v[112:113], v[112:113], v[104:105]
    v_pk_mul_f32 v[114:115], v[114:115], v[106:107]
    v_pk_mul_f32 v[116:117], v[116:117], v[100:101]
    v_pk_mul_f32 v[118:119], v[118:119], v[102:103]
    v_pk_mul_f32 v[120:121], v[120:121], v[104:105]
    v_pk_mul_f32 v[122:123], v[122:123], v[106:107]
    v_cvt_pk_bf16_f32 v108, 0, v108
    v_cvt_pk_bf16_f32 v109, 0, v109
    v_cvt_pk_bf16_f32 v110, 0, v110
    v_cvt_pk_bf16_f32 v111, 0, v111
    v_cvt_pk_bf16_f32 v112, 0, v112
    v_cvt_pk_bf16_f32 v113, 0, v113
    v_cvt_pk_bf16_f32 v114, 0, v114
    v_cvt_pk_bf16_f32 v115, 0, v115
    v_cvt_pk_bf16_f32 v116, 0, v116
    v_cvt_pk_bf16_f32 v117, 0, v117
    v_cvt_pk_bf16_f32 v118, 0, v118
    v_cvt_pk_bf16_f32 v119, 0, v119
    v_cvt_pk_bf16_f32 v120, 0, v120
    v_cvt_pk_bf16_f32 v121, 0, v121
    v_cvt_pk_bf16_f32 v122, 0, v122
    v_cvt_pk_bf16_f32 v123, 0, v123
    v_pk_add_f32 v[108:109], v[108:109], v[110:111]
    v_pk_add_f32 v[112:113], v[112:113], v[114:115]
    v_pk_add_f32 v[116:117], v[116:117], v[118:119]
    v_pk_add_f32 v[120:121], v[120:121], v[122:123]
    v_pk_add_f32 v[108:109], v[108:109], v[112:113]
    v_pk_add_f32 v[116:117], v[116:117], v[120:121]
    v_add_f32 v108, v108, v109
    v_add_f32 v116, v116, v117
    s_nop 0
    v_add_f32_dpp v108, v108, v108 quad_perm:[1,0,3,2] row_mask:0xf bank_mask:0xf
    v_add_f32_dpp v116, v116, v116 quad_perm:[1,0,3,2] row_mask:0xf bank_mask:0xf
    s_nop 0
    v_add_f32_dpp v108, v108, v108 quad_perm:[2,3,0,1] row_mask:0xf bank_mask:0xf
    v_add_f32_dpp v116, v116, v116 quad_perm:[2,3,0,1] row_mask:0xf bank_mask:0xf
    s_nop 0
    v_add_f32_dpp v108, v108, v108 row_half_mirror row_mask:0xf bank_mask:0xf
    v_add_f32_dpp v116, v116, v116 row_half_mirror row_mask:0xf bank_mask:0xf
    s_nop 0
    v_add_f32_dpp v108, v108, v108 row_mirror row_mask:0xf bank_mask:0xf
    v_add_f32_dpp v116, v116, v116 row_mirror row_mask:0xf bank_mask:0xf
    s_nop 0
    v_add_f32_dpp v108, v108, v108 row_bcast:15 row_mask:0xa bank_mask:0xf
    v_add_f32_dpp v116, v116, v116 row_bcast:15 row_mask:0xa bank_mask:0xf
    s_nop 0
    v_add_f32_dpp v108, v108, v108 row_bcast:31 row_mask:0xc bank_mask:0xf
    v_add_f32_dpp v116, v116, v116 row_bcast:31 row_mask:0xc bank_mask:0xf
    s_nop 0
    v_cvt_pk_bf16_f32 v108, 0, v108
    v_cvt_pk_bf16_f32 v116, 0, v116
    v_mul_f32 v108, 0xbfb8aa3b, v108
    v_mul_f32 v116, 0xbfb8aa3b, v116
    v_exp_f32 v108, v108
    v_exp_f32 v116, v116
    s_nop 0
    v_add_f32 v108, 1.0, v108
    v_add_f32 v116, 1.0, v116
    v_rcp_f32 v108, v108
    v_rcp_f32 v116, v116
    s_nop 0
    v_cvt_pk_bf16_f32 v108, 0, v108
    v_cvt_pk_bf16_f32 v116, 0, v116
    v_sub_f32 v109, 1.0, v108
    v_sub_f32 v117, 1.0, v116
    v_cvt_pk_bf16_f32 v100, v108, v109
    v_mov_b32 v101, s14
    v_cvt_pk_bf16_f32 v102, v116, v117
    v_mov_b32 v103, s14
    s_mov_b32 exec_lo, 0
    s_mov_b32 exec_hi, 0x80000000
    buffer_store_dwordx4 v[100:103], v7, s[64:67], 0 offen sc1
    s_mov_b64 exec, -1
    s_cmp_lg_u32 s100, 0
    s_cbranch_scc1 L_noslowflag
    v_mov_b32 v12, 134592
    s_mov_b32 s91, 0
L_sfspin:
    ds_read_b32 v8, v12
    s_add_u32 s91, s91, 1
    s_waitcnt lgkmcnt(0)
    v_readfirstlane_b32 s8, v8
    s_cmp_ge_u32 s91, 0x200000
    s_cbranch_scc1 L_sfspin_done
    s_cmp_ge_u32 s8, 4
    s_cbranch_scc1 L_sfspin_done
    s_sleep 1
    s_branch L_sfspin
L_sfspin_done:
    s_lshl_b32 s8, s7, 12
    s_lshl_b32 s9, s98, 7
    s_add_u32 s8, s8, s9
    s_add_u32 s8, s8, 0x418000
    v_lshl_add_u32 v8, v1, 3, s8
    s_mov_b64 exec, 0xffff
    buffer_store_dwordx2 v[52:53], v8, s[64:67], 0 offen sc1
    s_mov_b64 exec, -1
L_noslowflag:
    s_mov_b32 s91, 0
L_kspin_a:
    ds_read_b32 v8, v164
    s_add_u32 s91, s91, 1
    s_waitcnt lgkmcnt(0)
    v_readfirstlane_b32 s8, v8
    s_cmp_ge_u32 s91, 0x200000
    s_cbranch_scc1 L_kspin_a_done
    s_cmp_ge_u32 s8, 2
    s_cbranch_scc1 L_kspin_a_done
    s_sleep 1
    s_branch L_kspin_a
L_kspin_a_done:
    ds_read_b64 v[100:101], v154
    ds_read_b64 v[102:103], v155
    ds_read_b64 v[104:105], v156
    ds_read_b64 v[106:107], v157
    ds_read_b64 v[108:109], v158
    ds_read_b64 v[110:111], v159
    ds_read_b64 v[112:113], v160
    ds_read_b64 v[114:115], v161
    ds_read_b64 v[116:117], v162
    s_waitcnt lgkmcnt(0)
    v_add_f32 v100, v100, v101
    v_add_f32 v102, v102, v103
    v_add_f32 v104, v104, v105
    v_add_f32 v106, v106, v107
    v_add_f32 v108, v108, v109
    v_add_f32 v110, v110, v111
    v_add_f32 v112, v112, v113
    v_add_f32 v114, v114, v115
    v_add_f32 v116, v116, v117
    v_cvt_pk_bf16_f32 v120, v100, v102
    v_cvt_pk_bf16_f32 v124, v102, v104
    v_cvt_pk_bf16_f32 v121, v104, v106
    v_cvt_pk_bf16_f32 v125, v106, v108
    v_cvt_pk_bf16_f32 v122, v108, v110
    v_cvt_pk_bf16_f32 v126, v110, v112
    v_cvt_pk_bf16_f32 v123, v112, v114
    v_cvt_pk_bf16_f32 v127, v114, v116
    ds_write_b128 v163, v[120:123] offset:12484
    ds_write_b128 v163, v[124:127] offset:8324
    ds_write2_b32 v163, v124, v125 offset0:0 offset1:1
    ds_write2_b32 v163, v126, v127 offset0:2 offset1:3
    v_add_u32 v163, 4160, v163
    ds_write2_b32 v163, v120, v121 offset0:0 offset1:1
    ds_write2_b32 v163, v122, v123 offset0:2 offset1:3
    s_waitcnt lgkmcnt(0)
    s_mov_b32 s10, 0x400000
    s_barrier
    s_setprio 2
    buffer_load_dwordx4 v[20:23], v128, s[64:67], s10 offen offset:0 sc1
    buffer_load_dwordx4 v[24:27], v128, s[64:67], s10 offen offset:16 sc1
    buffer_load_dwordx4 v[28:31], v129, s[64:67], s10 offen offset:0 sc1
    buffer_load_dwordx4 v[32:35], v130, s[64:67], s10 offen offset:0 sc1
    ds_read_b64 v[36:37], v133 offset:21744
    ds_read_b64 v[40:41], v133 offset:47680
    ds_read_b64 v[44:45], v138 offset:21744
    ds_read_b64 v[48:49], v138 offset:47680
    ds_read_b32 v38, v134 offset:21744
    ds_read_b32 v42, v134 offset:47680
    ds_read_b32 v46, v139 offset:21744
    ds_read_b32 v50, v139 offset:47680
    ds_read_b32 v39, v135 offset:21744
    ds_read_b32 v43, v135 offset:47680
    ds_read_b32 v47, v140 offset:21744
    ds_read_b32 v51, v140 offset:47680
    s_waitcnt lgkmcnt(0)
    v_lshlrev_b32 v52, 16, v36
    v_lshlrev_b32 v56, 16, v44
    v_lshlrev_b32 v53, 16, v40
    v_lshlrev_b32 v57, 16, v48
    v_mul_f32 v54, s82, v52
    v_mul_f32 v56, s84, v56
    v_mul_f32 v55, s83, v53
    v_mul_f32 v57, s85, v57
    v_and_b32 v58, s50, v36
    v_and_b32 v62, s50, v44
    v_and_b32 v59, s50, v40
    v_and_b32 v63, s50, v48
    v_mul_f32 v60, s82, v58
    v_mul_f32 v62, s84, v62
    v_mul_f32 v61, s83, v59
    v_mul_f32 v63, s85, v63
    v_lshlrev_b32 v64, 16, v37
    v_lshlrev_b32 v68, 16, v45
    v_lshlrev_b32 v65, 16, v41
    v_lshlrev_b32 v69, 16, v49
    v_mul_f32 v66, s82, v64
    v_mul_f32 v68, s84, v68
    v_mul_f32 v67, s83, v65
    v_mul_f32 v69, s85, v69
    v_and_b32 v70, s50, v37
    v_and_b32 v74, s50, v45
    v_and_b32 v71, s50, v41
    v_and_b32 v75, s50, v49
    v_mul_f32 v72, s82, v70
    v_mul_f32 v74, s84, v74
    v_mul_f32 v73, s83, v71
    v_mul_f32 v75, s85, v75
    v_lshlrev_b32 v76, 16, v38
    v_lshlrev_b32 v80, 16, v46
    v_lshlrev_b32 v77, 16, v42
    v_lshlrev_b32 v81, 16, v50
    v_mul_f32 v78, s82, v76
    v_mul_f32 v80, s84, v80
    v_mul_f32 v79, s83, v77
    v_mul_f32 v81, s85, v81
    v_and_b32 v82, s50, v38
    v_and_b32 v86, s50, v46
    v_and_b32 v83, s50, v42
    v_and_b32 v87, s50, v50
    v_mul_f32 v84, s82, v82
    v_mul_f32 v86, s84, v86
    v_mul_f32 v85, s83, v83
    v_mul_f32 v87, s85, v87
    v_lshlrev_b32 v88, 16, v39
    v_lshlrev_b32 v92, 16, v47
    v_lshlrev_b32 v89, 16, v43
    v_lshlrev_b32 v93, 16, v51
    v_mul_f32 v90, s82, v88
    v_mul_f32 v92, s84, v92
    v_mul_f32 v91, s83, v89
    v_mul_f32 v93, s85, v93
    v_and_b32 v94, s50, v39
    v_and_b32 v98, s50, v47
    v_and_b32 v95, s50, v43
    v_and_b32 v99, s50, v51
    v_mul_f32 v96, s82, v94
    v_mul_f32 v98, s84, v98
    v_mul_f32 v97, s83, v95
    v_mul_f32 v99, s85, v99
    s_mov_b32 s91, 0
    s_branch L_gchk
L_gpoll:
    s_sleep 4
    buffer_load_dwordx4 v[20:23], v128, s[64:67], s10 offen offset:0 sc1
    buffer_load_dwordx4 v[24:27], v128, s[64:67], s10 offen offset:16 sc1
    buffer_load_dwordx4 v[28:31], v129, s[64:67], s10 offen offset:0 sc1
    buffer_load_dwordx4 v[32:35], v130, s[64:67], s10 offen offset:0 sc1
    s_add_u32 s91, s91, 1
L_gchk:
    s_waitcnt vmcnt(0)
    v_xor_b32 v8, s14, v21
    v_xor_b32 v9, s14, v23
    v_or_b32 v8, v8, v9
    v_xor_b32 v9, s14, v25
    v_or_b32 v8, v8, v9
    v_xor_b32 v9, s14, v27
    v_or_b32 v8, v8, v9
    v_xor_b32 v9, s14, v29
    v_or_b32 v8, v8, v9
    v_xor_b32 v9, s14, v31
    v_or_b32 v8, v8, v9
    v_xor_b32 v9, s14, v33
    v_or_b32 v8, v8, v9
    v_xor_b32 v9, s14, v35
    v_or_b32 v8, v8, v9
    v_cmp_ne_u32 vcc, 0, v8
    s_cmp_ge_u32 s91, 0x40000
    s_cbranch_scc1 L_gpoll_done
    s_cmp_eq_u64 vcc, 0
    s_cbranch_scc0 L_gpoll
L_gpoll_done:
    v_and_b32 v21, s50, v20
    v_lshlrev_b32 v20, 16, v20
    v_mul_f32 v52, v52, v21
    v_mul_f32 v54, v54, v20
    v_mul_f32 v53, v53, v21
    v_mul_f32 v55, v55, v20
    v_fmac_f32 v54, v56, v52
    v_fmac_f32 v55, v57, v53
    v_and_b32 v23, s50, v22
    v_lshlrev_b32 v22, 16, v22
    v_mul_f32 v58, v58, v23
    v_mul_f32 v60, v60, v22
    v_mul_f32 v59, v59, v23
    v_mul_f32 v61, v61, v22
    v_fmac_f32 v60, v62, v58
    v_fmac_f32 v61, v63, v59
    v_and_b32 v25, s50, v24
    v_lshlrev_b32 v24, 16, v24
    v_mul_f32 v64, v64, v25
    v_mul_f32 v66, v66, v24
    v_mul_f32 v65, v65, v25
    v_mul_f32 v67, v67, v24
    v_fmac_f32 v66, v68, v64
    v_fmac_f32 v67, v69, v65
    v_and_b32 v27, s50, v26
    v_lshlrev_b32 v26, 16, v26
    v_mul_f32 v70, v70, v27
    v_mul_f32 v72, v72, v26
    v_mul_f32 v71, v71, v27
    v_mul_f32 v73, v73, v26
    v_fmac_f32 v72, v74, v70
    v_fmac_f32 v73, v75, v71
    v_and_b32 v29, s50, v28
    v_lshlrev_b32 v28, 16, v28
    v_mul_f32 v76, v76, v29
    v_mul_f32 v78, v78, v28
    v_mul_f32 v77, v77, v29
    v_mul_f32 v79, v79, v28
    v_fmac_f32 v78, v80, v76
    v_fmac_f32 v79, v81, v77
    v_and_b32 v31, s50, v30
    v_lshlrev_b32 v30, 16, v30
    v_mul_f32 v82, v82, v31
    v_mul_f32 v84, v84, v30
    v_mul_f32 v83, v83, v31
    v_mul_f32 v85, v85, v30
    v_fmac_f32 v84, v86, v82
    v_fmac_f32 v85, v87, v83
    v_and_b32 v33, s50, v32
    v_lshlrev_b32 v32, 16, v32
    v_mul_f32 v88, v88, v33
    v_mul_f32 v90, v90, v32
    v_mul_f32 v89, v89, v33
    v_mul_f32 v91, v91, v32
    v_fmac_f32 v90, v92, v88
    v_fmac_f32 v91, v93, v89
    v_and_b32 v35, s50, v34
    v_lshlrev_b32 v34, 16, v34
    v_mul_f32 v94, v94, v35
    v_mul_f32 v96, v96, v34
    v_mul_f32 v95, v95, v35
    v_mul_f32 v97, v97, v34
    v_fmac_f32 v96, v98, v94
    v_fmac_f32 v97, v99, v95
    v_mov_b32 v5, 134624
    s_mov_b32 s91, 0
L_yspin0:
    ds_read_b128 v[104:107], v5 offset:0
    s_add_u32 s91, s91, 1
    s_waitcnt lgkmcnt(0)
    v_min_u32 v104, v104, v105
    v_min3_u32 v104, v104, v106, v107
    s_cmp_ge_u32 s91, 0x200000
    v_readfirstlane_b32 s8, v104
    s_cbranch_scc1 L_yspin0_done
    s_cmp_lg_u32 s8, 0
    s_cbranch_scc1 L_yspin0_done
    s_sleep 1
    s_branch L_yspin0
L_yspin0_done:
    ds_read_b64 v[108:109], v143 offset:0
    ds_read_b64 v[110:111], v143 offset:4608
    ds_read_b64 v[112:113], v143 offset:9216
    ds_read_b64 v[114:115], v143 offset:13824
    s_waitcnt lgkmcnt(0)
    v_lshlrev_b32 v116, 16, v108
    v_lshlrev_b32 v118, 16, v112
    v_lshlrev_b32 v117, 16, v110
    v_lshlrev_b32 v119, 16, v114
    v_fmac_f32 v54, v116, v20
    v_fmac_f32 v55, v117, v20
    v_fmac_f32 v54, v118, v52
    v_fmac_f32 v55, v119, v53
    v_cvt_pk_bf16_f32 v54, v54, v55
    buffer_store_dword v54, v148, s[68:71], 0 offen offset:0
    v_and_b32 v120, s50, v108
    v_and_b32 v122, s50, v112
    v_and_b32 v121, s50, v110
    v_and_b32 v123, s50, v114
    v_fmac_f32 v60, v120, v22
    v_fmac_f32 v61, v121, v22
    v_fmac_f32 v60, v122, v58
    v_fmac_f32 v61, v123, v59
    v_cvt_pk_bf16_f32 v60, v60, v61
    buffer_store_dword v60, v148, s[68:71], 0 offen offset:1024
    v_lshlrev_b32 v116, 16, v109
    v_lshlrev_b32 v118, 16, v113
    v_lshlrev_b32 v117, 16, v111
    v_lshlrev_b32 v119, 16, v115
    v_fmac_f32 v66, v116, v24
    v_fmac_f32 v67, v117, v24
    v_fmac_f32 v66, v118, v64
    v_fmac_f32 v67, v119, v65
    v_cvt_pk_bf16_f32 v66, v66, v67
    buffer_store_dword v66, v148, s[68:71], 0 offen offset:2048
    v_and_b32 v120, s50, v109
    v_and_b32 v122, s50, v113
    v_and_b32 v121, s50, v111
    v_and_b32 v123, s50, v115
    v_fmac_f32 v72, v120, v26
    v_fmac_f32 v73, v121, v26
    v_fmac_f32 v72, v122, v70
    v_fmac_f32 v73, v123, v71
    v_cvt_pk_bf16_f32 v72, v72, v73
    buffer_store_dword v72, v148, s[68:71], 0 offen offset:3072
    s_mov_b32 s91, 0
L_yspin1:
    ds_read_b128 v[104:107], v5 offset:16
    s_add_u32 s91, s91, 1
    s_waitcnt lgkmcnt(0)
    v_min_u32 v104, v104, v105
    v_min3_u32 v104, v104, v106, v107
    s_cmp_ge_u32 s91, 0x200000
    v_readfirstlane_b32 s8, v104
    s_cbranch_scc1 L_yspin1_done
    s_cmp_lg_u32 s8, 0
    s_cbranch_scc1 L_yspin1_done
    s_sleep 1
    s_branch L_yspin1
L_yspin1_done:
    ds_read_b32 v108, v144 offset:0
    ds_read_b32 v110, v144 offset:4608
    ds_read_b32 v112, v144 offset:9216
    ds_read_b32 v114, v144 offset:13824
    s_waitcnt lgkmcnt(0)
    v_lshlrev_b32 v116, 16, v108
    v_lshlrev_b32 v118, 16, v112
    v_lshlrev_b32 v117, 16, v110
    v_lshlrev_b32 v119, 16, v114
    v_fmac_f32 v78, v116, v28
    v_fmac_f32 v79, v117, v28
    v_fmac_f32 v78, v118, v76
    v_fmac_f32 v79, v119, v77
    v_cvt_pk_bf16_f32 v78, v78, v79
    buffer_store_dword v78, v149, s[68:71], 0 offen offset:0
    v_and_b32 v120, s50, v108
    v_and_b32 v122, s50, v112
    v_and_b32 v121, s50, v110
    v_and_b32 v123, s50, v114
    v_fmac_f32 v84, v120, v30
    v_fmac_f32 v85, v121, v30
    v_fmac_f32 v84, v122, v82
    v_fmac_f32 v85, v123, v83
    v_cvt_pk_bf16_f32 v84, v84, v85
    buffer_store_dword v84, v149, s[68:71], 0 offen offset:1024
    s_mov_b32 s91, 0
L_yspin2:
    ds_read_b128 v[104:107], v5 offset:32
    s_add_u32 s91, s91, 1
    s_waitcnt lgkmcnt(0)
    v_min_u32 v104, v104, v105
    v_min3_u32 v104, v104, v106, v107
    s_cmp_ge_u32 s91, 0x200000
    v_readfirstlane_b32 s8, v104
    s_cbranch_scc1 L_yspin2_done
    s_cmp_lg_u32 s8, 0
    s_cbranch_scc1 L_yspin2_done
    s_sleep 1
    s_branch L_yspin2
L_yspin2_done:
    ds_read_b32 v108, v145 offset:0
    ds_read_b32 v110, v145 offset:4608
    ds_read_b32 v112, v145 offset:9216
    ds_read_b32 v114, v145 offset:13824
    s_waitcnt lgkmcnt(0)
    v_lshlrev_b32 v116, 16, v108
    v_lshlrev_b32 v118, 16, v112
    v_lshlrev_b32 v117, 16, v110
    v_lshlrev_b32 v119, 16, v114
    v_fmac_f32 v90, v116, v32
    v_fmac_f32 v91, v117, v32
    v_fmac_f32 v90, v118, v88
    v_fmac_f32 v91, v119, v89
    v_cvt_pk_bf16_f32 v90, v90, v91
    buffer_store_dword v90, v150, s[68:71], 0 offen offset:0
    v_and_b32 v120, s50, v108
    v_and_b32 v122, s50, v112
    v_and_b32 v121, s50, v110
    v_and_b32 v123, s50, v114
    v_fmac_f32 v96, v120, v34
    v_fmac_f32 v97, v121, v34
    v_fmac_f32 v96, v122, v94
    v_fmac_f32 v97, v123, v95
    v_cvt_pk_bf16_f32 v96, v96, v97
    buffer_store_dword v96, v150, s[68:71], 0 offen offset:1024
L_end:
    s_endpgm
.section .rodata,"a"
.p2align 6
.amdhsa_kernel gated_mix__ssm_conv_s4d__ssm_conv_h3__prompt_kernel
  .amdhsa_next_free_vgpr 168
  .amdhsa_next_free_sgpr 102
  .amdhsa_accum_offset 168
  .amdhsa_group_segment_fixed_size 0
  .amdhsa_kernarg_size 136
  .amdhsa_user_sgpr_count 2
  .amdhsa_user_sgpr_kernarg_segment_ptr 1
  .amdhsa_system_sgpr_workgroup_id_x 1
  .amdhsa_float_denorm_mode_32 3
.end_amdhsa_kernel
```
